```python
import torch

def _softmax(x, axis=-1):
    return torch.softmax(x, dim=axis)
def _gelu(x):
    return torch.nn.functional.gelu(x, approximate="tanh")
def _silu(x):
    return torch.nn.functional.silu(x)
def _sigmoid(x):
    return torch.sigmoid(x)
def _layernorm(x, axis=-1, eps=1e-5):
    m = x.mean(dim=axis, keepdim=True)
    v = x.var(dim=axis, keepdim=True, unbiased=False)
    return (x - m) / torch.sqrt(v + eps)
def _scatter_add(tgt, idx, src, axis=0):
    return tgt.clone().index_add_(axis, idx, src)
def _segment_sum(src, seg, n):
    out = torch.zeros((n,) + src.shape[1:], dtype=src.dtype)
    return out.index_add_(0, seg, src)
def _pad(x, pw):
    flat = tuple(v for pair in reversed(pw) for v in pair)
    return torch.nn.functional.pad(x, flat)

kernel_name = 'standalone__deep_cross_xdeepfm__recsys'

def setup_inputs():

    _w = (lambda a: (lambda t: t.to(torch.bfloat16) if t.is_floating_point() else t)(torch.as_tensor(a)))
    B, F, D, L = 1024, 26, 64, 3
    V = min(1000, 100000)
    Din = F * D
    return {
        "idx": _w((lambda lo, hi, *s: torch.randint(lo, hi, s))(0, V, B, F).to(torch.int64)),
        "table": _w((lambda *s: torch.randn(*s, dtype=torch.bfloat16) * 0.8)(V, D)),
        "ws_cin": _w((lambda *s: torch.randn(*s, dtype=torch.bfloat16) * 0.2)(L, F, F, F) * (1.0 / F)),
        "w_cin_out": _w((lambda *s: torch.randn(*s, dtype=torch.bfloat16) * 0.2)(L * F) * ((L * F) ** -0.5)),
        "w_dnn1": _w((lambda *s: torch.randn(*s, dtype=torch.bfloat16) * 0.8)(Din, Din) * (Din ** -0.5)),
        "b_dnn1": _w((lambda *s: torch.randn(*s, dtype=torch.bfloat16) * 6.4)(Din) * 0.1),
        "w_dnn2": _w((lambda *s: torch.randn(*s, dtype=torch.bfloat16) * 0.2)(Din) * (Din ** -0.5)),
        "b_out": _w((lambda *s: torch.randn(*s, dtype=torch.bfloat16) * 0.4)(1)),
    }

def reference(idx, table, ws_cin, w_cin_out, w_dnn1, b_dnn1, w_dnn2, b_out):
    x0 = table[idx]
    B = x0.shape[0]
    L = ws_cin.shape[0]
    xk = x0
    pooled = []
    for l in range(L):
        xk = torch.einsum('bid,bjd,hij->bhd', xk, x0, ws_cin[l])
        pooled.append(xk.sum(axis=-1))
    p_plus = torch.stack(pooled, axis=1).reshape(B, -1)
    logit_cin = p_plus @ w_cin_out
    h = x0.reshape(B, -1)
    h = _gelu(h @ w_dnn1 + b_dnn1)
    logit_dnn = h @ w_dnn2
    return logit_cin + logit_dnn + b_out
```

```asm
; @launch grid=(256,1,1) block=(512,1,1) lds=163840
.amdgcn_target "amdgcn-amd-amdhsa--gfx950"
.text
.globl standalone__deep_cross_xdeepfm__recsys_kernel
.p2align 8
.type standalone__deep_cross_xdeepfm__recsys_kernel,@function
standalone__deep_cross_xdeepfm__recsys_kernel:
    s_load_dwordx16 s[4:19], s[0:1], 0
    s_load_dwordx4 s[20:23], s[0:1], 64
    s_load_dwordx2 s[24:25], s[0:1], 80
    s_cmp_ge_u32 s2, 256
    s_cbranch_scc1 L_exit
    v_lshrrev_b32 v8, 6, v0
    v_and_b32 v1, 63, v0
    v_readfirstlane_b32 s86, v8
    s_mov_b32 s92, 0x1000000
    s_and_b32 s41, s2, 7
    s_lshr_b32 s43, s2, 3
    s_and_b32 s40, s86, 3
    s_cmp_lg_u32 s86, 7
    s_cbranch_scc1 L_nopf
    s_getpc_b64 s[90:91]
L_pf0:
    s_min_u32 s58, s43, (L_exit-L_pf0)/1024-1
    s_lshl_b32 s58, s58, 10
    v_lshl_add_u32 v8, v1, 4, s58
    global_load_dwordx4 v[16:19], v8, s[90:91]
L_nopf:
    s_movk_i32 s44, 26
    s_mul_i32 s46, s41, 26
    s_cmp_ge_u32 s43, s44
    s_cbranch_scc1 L_helper
    s_lshl_b32 s93, s41, 5
    s_add_u32 s93, s93, s43
    s_add_u32 s41, s46, s43
    s_and_b32 s42, s41, 7
    s_lshr_b32 s41, s41, 3
    v_lshlrev_b32 v9, 4, v1
    s_lshl_b32 s58, s86, 11
    s_mul_i32 s60, s42, 13312
    s_add_u32 s60, s60, s58
    s_add_u32 m0, s58, 147456
    s_add_u32 s94, s60, 1024
    s_mul_i32 s59, s93, 416
    s_cmp_eq_u32 s86, 6
    s_cselect_b32 s94, s59, s94
    s_mov_b32 s30, 106496
    s_cmp_eq_u32 s86, 7
    s_cselect_b32 s30, 0, s30
    s_mov_b32 s31, 0x20000
    s_mov_b32 s34, 128000
    s_mov_b32 s35, 0x20000
    v_lshrrev_b32 v10, 3, v1
    v_and_b32 v11, 7, v1
    v_lshrrev_b32 v12, 1, v10
    v_xor_b32 v13, v11, v12
    v_lshlrev_b32 v13, 4, v13
    v_lshl_add_u32 v2, v10, 7, v13
    v_xor_b32 v3, 64, v2
    s_mul_i32 s3, s43, 4
    s_add_u32 s3, s3, s86
    s_waitcnt lgkmcnt(0)
    s_mov_b32 s28, s4
    s_mov_b32 s29, s5
    buffer_load_dwordx4 v9, s[28:31], s60 offen lds
    s_mov_b32 s32, s6
    s_mov_b32 s33, s7
    s_add_u32 m0, m0, 1024
    s_nop 0
    buffer_load_dwordx4 v9, s[28:31], s94 offen lds
    s_and_b32 s96, s3, 31
    s_lshl_b32 s96, s96, 12
    s_mov_b32 m0, s96
    s_add_u32 s3, s3, 8
    buffer_load_dwordx4 v2, s[32:35], s96 offen offset:0  lds
    s_lshl_b32 s58, s86, 8
    s_add_u32 s58, s58, 128000
    buffer_load_dwordx4 v3, s[32:35], s96 offen offset:1024  lds
    v_lshl_add_u32 v14, v1, 2, s58
    v_mov_b32 v15, 0
    buffer_load_dwordx4 v2, s[32:35], s96 offen offset:2048  lds
    ds_write_b32 v14, v15
    buffer_load_dwordx4 v3, s[32:35], s96 offen offset:3072  lds
    s_and_b32 s96, s3, 31
    s_lshl_b32 s96, s96, 12
    s_mov_b32 m0, s96
    s_add_u32 s3, s3, 8
    buffer_load_dwordx4 v2, s[32:35], s96 offen offset:0  lds
    buffer_load_dwordx4 v3, s[32:35], s96 offen offset:1024  lds
    buffer_load_dwordx4 v2, s[32:35], s96 offen offset:2048  lds
    buffer_load_dwordx4 v3, s[32:35], s96 offen offset:3072  lds
    s_cmp_ge_u32 s86, 4
    s_cbranch_scc1 L_cwave
    s_setprio 1
    s_and_b32 s61, s42, 7
    s_mul_i32 s61, s61, 12
    s_lshr_b32 s61, s61, 3
    s_lshr_b32 s46, s40, 1
    s_and_b32 s47, s40, 1
    s_lshl_b32 s61, s61, 2
    v_and_b32 v10, 31, v1
    v_mul_u32_u24 v8, 104, v10
    s_lshl_b32 s48, s47, 1
    s_add_u32 s48, s48, s46
    v_lshrrev_b32 v11, 5, v1
    v_xor_b32 v12, s48, v11
    v_mul_u32_u24 v12, 3328, v12
    s_mul_i32 s59, s46, 52
    s_add_u32 s59, s59, 147456
    v_add3_u32 v12, v12, v8, s59
    s_add_u32 s58, s61, 0
    s_sub_u32 s59, s58, 52
    s_min_u32 s58, s58, s59
    v_add_u32 v160, s58, v12
    s_add_u32 s58, s61, 4
    s_sub_u32 s59, s58, 52
    s_min_u32 s58, s58, s59
    v_add_u32 v162, s58, v12
    s_add_u32 s58, s61, 8
    s_sub_u32 s59, s58, 52
    s_min_u32 s58, s58, s59
    v_add_u32 v164, s58, v12
    s_add_u32 s58, s61, 12
    s_sub_u32 s59, s58, 52
    s_min_u32 s58, s58, s59
    v_add_u32 v166, s58, v12
    s_add_u32 s58, s61, 16
    s_sub_u32 s59, s58, 52
    s_min_u32 s58, s58, s59
    v_add_u32 v168, s58, v12
    s_add_u32 s58, s61, 20
    s_sub_u32 s59, s58, 52
    s_min_u32 s58, s58, s59
    v_add_u32 v170, s58, v12
    s_add_u32 s58, s61, 24
    s_sub_u32 s59, s58, 52
    s_min_u32 s58, s58, s59
    v_add_u32 v172, s58, v12
    s_add_u32 s58, s61, 28
    s_sub_u32 s59, s58, 52
    s_min_u32 s58, s58, s59
    v_add_u32 v174, s58, v12
    s_add_u32 s58, s61, 32
    s_sub_u32 s59, s58, 52
    s_min_u32 s58, s58, s59
    v_add_u32 v176, s58, v12
    s_add_u32 s58, s61, 36
    s_sub_u32 s59, s58, 52
    s_min_u32 s58, s58, s59
    v_add_u32 v178, s58, v12
    s_add_u32 s58, s61, 40
    s_sub_u32 s59, s58, 52
    s_min_u32 s58, s58, s59
    v_add_u32 v180, s58, v12
    s_add_u32 s58, s61, 44
    s_sub_u32 s59, s58, 52
    s_min_u32 s58, s58, s59
    v_add_u32 v182, s58, v12
    s_add_u32 s58, s61, 48
    s_sub_u32 s59, s58, 52
    s_min_u32 s58, s58, s59
    v_add_u32 v184, s58, v12
    v_bfe_u32 v8, v1, 2, 2
    v_lshl_add_u32 v12, v11, 3, v8
    v_lshlrev_b32 v12, 7, v12
    v_bfe_u32 v13, v1, 4, 1
    v_lshl_add_u32 v12, v13, 5, v12
    v_and_b32 v13, 3, v1
    v_lshl_add_u32 v12, v13, 3, v12
    v_lshrrev_b32 v13, 1, v8
    v_lshlrev_b32 v13, 6, v13
    v_xor_b32 v12, v12, v13
    s_lshl_b32 s58, s46, 12
    s_add_u32 s58, s58, 131072
    v_add_u32 v6, s58, v12
    v_xor_b32 v7, 64, v6
    v_lshlrev_b32 v11, 4, v11
    s_movk_i32 s59, 0x70
    s_mov_b32 s88, s14
    s_mov_b32 s89, s15
    s_mov_b32 s90, 3328
    s_mov_b32 s91, 0x20000
    v_lshlrev_b32 v8, 1, v10
    v_mov_b32 v13, 2147483647
    v_cmp_gt_u32 vcc, 32, v1
    s_nop 1
    v_cndmask_b32 v8, v13, v8, vcc
    s_lshl_b32 s60, s41, 7
    v_mov_b32 v12, 0x3f80
    v_cndmask_b32 v212, 0, v12, vcc
    v_mov_b32 v205, 0
    v_mov_b32 v206, 0
    v_mov_b32 v207, 0
    v_mov_b32 v209, 0
    v_mov_b32 v210, 0
    v_mov_b32 v211, 0
    v_mov_b32 v213, 0
    v_mov_b32 v214, 0
    v_mov_b32 v215, 0
    buffer_load_ushort v204, v8, s[88:91], s60 offen
    buffer_load_ushort v208, v8, s[88:91], s60 offen offset:64
    v_lshrrev_b32 v12, 1, v11
    v_lshlrev_b32 v4, 3, v1
    v_cndmask_b32 v4, v13, v4, vcc
    s_add_u32 s28, s24, 65536
    s_addc_u32 s29, s25, 0
    s_mov_b32 s30, 212992
    s_mov_b32 s31, 0x20000
    s_lshl_b32 s61, s42, 7
    s_lshl_b32 s59, s48, 5
    s_add_u32 s61, s61, s59
    s_lshl_b32 s61, s61, 3
    s_lshl_b32 s59, s41, 13
    s_add_u32 s61, s61, s59
    s_lshl_b32 s58, s40, 13
    v_add_u32 v14, s58, v9
    s_xor_b32 s58, s58, 16384
    v_add_u32 v15, s58, v9
    s_lshl_b32 s58, s40, 12
    s_add_u32 s59, s58, 131072
    v_add_u32 v186, s59, v9
    v_xor_b32 v187, 8192, v186
    s_and_b32 s96, s3, 31
    s_lshl_b32 s96, s96, 12
    s_mov_b32 m0, s96
    s_add_u32 s3, s3, 8
    buffer_load_dwordx4 v2, s[32:35], s96 offen offset:0  lds
    s_waitcnt vmcnt(11)
    s_barrier
    ds_read_b32 v160, v160
    ds_read_b32 v162, v162
    ds_read_b32 v164, v164
    buffer_load_dwordx4 v3, s[32:35], s96 offen offset:1024  lds
    ds_read_b32 v166, v166
    ds_read_b32 v168, v168
    ds_read_b32 v170, v170
    ds_read_b32 v172, v172
    buffer_load_dwordx4 v2, s[32:35], s96 offen offset:2048  lds
    ds_read_b32 v174, v174
    ds_read_b32 v176, v176
    ds_read_b32 v178, v178
    ds_read_b32 v180, v180
    buffer_load_dwordx4 v3, s[32:35], s96 offen offset:3072  lds
    ds_read_b32 v182, v182
    ds_read_b32 v184, v184
    s_waitcnt lgkmcnt(12)
    v_lshlrev_b32 v112, 3, v160
    s_waitcnt lgkmcnt(11)
    v_lshlrev_b32 v113, 3, v162
    s_and_b32 s96, s3, 31
    s_lshl_b32 s96, s96, 12
    s_mov_b32 m0, s96
    s_add_u32 s3, s3, 8
    buffer_load_dwordx4 v2, s[32:35], s96 offen offset:0  lds
    v_and_b32 v112, 0x70, v112
    v_and_b32 v113, 0x70, v113
    v_lshl_add_u32 v160, v160, 7, v112
    v_lshl_add_u32 v162, v162, 7, v113
    buffer_load_dwordx4 v3, s[32:35], s96 offen offset:1024  lds
    v_xor_b32 v161, 16, v160
    v_xor_b32 v163, 16, v162
    s_waitcnt lgkmcnt(10)
    v_lshlrev_b32 v112, 3, v164
    s_waitcnt lgkmcnt(9)
    v_lshlrev_b32 v113, 3, v166
    buffer_load_dwordx4 v2, s[32:35], s96 offen offset:2048  lds
    v_and_b32 v112, 0x70, v112
    v_and_b32 v113, 0x70, v113
    v_lshl_add_u32 v164, v164, 7, v112
    v_lshl_add_u32 v166, v166, 7, v113
    buffer_load_dwordx4 v3, s[32:35], s96 offen offset:3072  lds
    v_xor_b32 v165, 16, v164
    v_xor_b32 v167, 16, v166
    v_permlane32_swap_b32 v160, v161
    v_permlane32_swap_b32 v162, v163
    s_waitcnt lgkmcnt(8)
    v_lshlrev_b32 v112, 3, v168
    s_waitcnt lgkmcnt(7)
    v_lshlrev_b32 v113, 3, v170
    v_and_b32 v112, 0x70, v112
    v_and_b32 v113, 0x70, v113
    v_lshl_add_u32 v168, v168, 7, v112
    v_lshl_add_u32 v170, v170, 7, v113
    v_xor_b32 v169, 16, v168
    v_xor_b32 v171, 16, v170
    v_permlane32_swap_b32 v164, v165
    v_permlane32_swap_b32 v166, v167
    s_waitcnt lgkmcnt(6)
    v_lshlrev_b32 v112, 3, v172
    s_waitcnt lgkmcnt(5)
    v_lshlrev_b32 v113, 3, v174
    v_and_b32 v112, 0x70, v112
    v_and_b32 v113, 0x70, v113
    v_lshl_add_u32 v172, v172, 7, v112
    v_lshl_add_u32 v174, v174, 7, v113
    v_xor_b32 v173, 16, v172
    v_xor_b32 v175, 16, v174
    v_permlane32_swap_b32 v168, v169
    v_permlane32_swap_b32 v170, v171
    s_waitcnt lgkmcnt(4)
    v_lshlrev_b32 v112, 3, v176
    s_waitcnt lgkmcnt(3)
    v_lshlrev_b32 v113, 3, v178
    v_and_b32 v112, 0x70, v112
    v_and_b32 v113, 0x70, v113
    v_lshl_add_u32 v176, v176, 7, v112
    v_lshl_add_u32 v178, v178, 7, v113
    v_xor_b32 v177, 16, v176
    v_xor_b32 v179, 16, v178
    v_permlane32_swap_b32 v172, v173
    v_permlane32_swap_b32 v174, v175
    s_waitcnt lgkmcnt(2)
    v_lshlrev_b32 v112, 3, v180
    s_waitcnt lgkmcnt(1)
    v_lshlrev_b32 v113, 3, v182
    v_and_b32 v112, 0x70, v112
    v_and_b32 v113, 0x70, v113
    v_lshl_add_u32 v180, v180, 7, v112
    v_lshl_add_u32 v182, v182, 7, v113
    v_xor_b32 v181, 16, v180
    v_xor_b32 v183, 16, v182
    v_permlane32_swap_b32 v176, v177
    v_permlane32_swap_b32 v178, v179
    s_waitcnt lgkmcnt(0)
    v_lshlrev_b32 v112, 3, v184
    v_and_b32 v112, 0x70, v112
    v_lshl_add_u32 v184, v184, 7, v112
    v_xor_b32 v185, 16, v184
    v_permlane32_swap_b32 v180, v181
    v_permlane32_swap_b32 v182, v183
    v_permlane32_swap_b32 v184, v185
    s_barrier
    s_waitcnt vmcnt(0)
    s_barrier
    ds_read_b128 v[112:115], v160
    ds_read_b64_tr_b16 v[80:81], v6 offset:0
    ds_read_b64_tr_b16 v[82:83], v6 offset:512
    ds_read_b128 v[116:119], v161
    ds_read_b64_tr_b16 v[84:85], v7 offset:0
    ds_read_b64_tr_b16 v[86:87], v7 offset:512
    v_xor_b32 v160, 32, v160
    ds_read_b128 v[120:123], v160
    ds_read_b64_tr_b16 v[88:89], v6 offset:2048
    ds_read_b64_tr_b16 v[90:91], v6 offset:2560
    v_xor_b32 v161, 32, v161
    ds_read_b128 v[124:127], v161
    ds_read_b64_tr_b16 v[92:93], v7 offset:2048
    ds_read_b64_tr_b16 v[94:95], v7 offset:2560
    v_mfma_f32_32x32x16_bf16 v[16:31], v[204:207], v[212:215], 0
    v_mfma_f32_32x32x16_bf16 v[32:47], v[208:211], v[212:215], 0
    s_waitcnt lgkmcnt(0)
    s_barrier
    v_mfma_f32_32x32x16_bf16 v[16:31], v[80:83], v[112:115], v[16:31]
    ds_read_b64_tr_b16 v[96:97], v6 offset:8192
    ds_read_b64_tr_b16 v[98:99], v6 offset:8704
    v_mfma_f32_32x32x16_bf16 v[32:47], v[84:87], v[112:115], v[32:47]
    v_xor_b32 v160, 96, v160
    ds_read_b128 v[128:131], v160
    ds_read_b64_tr_b16 v[100:101], v7 offset:8192
    v_mfma_f32_32x32x16_bf16 v[48:63], v[80:83], v[116:119], 0
    ds_read_b64_tr_b16 v[102:103], v7 offset:8704
    ds_read_b64_tr_b16 v[104:105], v6 offset:10240
    ds_read_b64_tr_b16 v[106:107], v6 offset:10752
    v_mfma_f32_32x32x16_bf16 v[64:79], v[84:87], v[116:119], 0
    v_xor_b32 v161, 96, v161
    ds_read_b128 v[132:135], v161
    v_mfma_f32_32x32x16_bf16 v[16:31], v[88:91], v[120:123], v[16:31]
    ds_read_b64_tr_b16 v[108:109], v7 offset:10240
    ds_read_b64_tr_b16 v[110:111], v7 offset:10752
    v_mfma_f32_32x32x16_bf16 v[32:47], v[92:95], v[120:123], v[32:47]
    v_xor_b32 v160, 32, v160
    ds_read_b128 v[136:139], v160
    v_mfma_f32_32x32x16_bf16 v[48:63], v[88:91], v[124:127], v[48:63]
    v_xor_b32 v161, 32, v161
    ds_read_b128 v[140:143], v161
    v_mfma_f32_32x32x16_bf16 v[64:79], v[92:95], v[124:127], v[64:79]
    s_waitcnt lgkmcnt(2)
    s_barrier
    v_mfma_f32_32x32x16_bf16 v[16:31], v[96:99], v[128:131], v[16:31]
    ds_read_b64_tr_b16 v[80:81], v6 offset:16384
    ds_read_b64_tr_b16 v[82:83], v6 offset:16896
    v_mfma_f32_32x32x16_bf16 v[32:47], v[100:103], v[128:131], v[32:47]
    ds_read_b128 v[144:147], v162
    ds_read_b64_tr_b16 v[84:85], v7 offset:16384
    v_mfma_f32_32x32x16_bf16 v[48:63], v[96:99], v[132:135], v[48:63]
    ds_read_b64_tr_b16 v[86:87], v7 offset:16896
    ds_read_b64_tr_b16 v[88:89], v6 offset:18432
    ds_read_b64_tr_b16 v[90:91], v6 offset:18944
    v_mfma_f32_32x32x16_bf16 v[64:79], v[100:103], v[132:135], v[64:79]
    ds_read_b128 v[148:151], v163
    s_waitcnt lgkmcnt(9)
    v_mfma_f32_32x32x16_bf16 v[16:31], v[104:107], v[136:139], v[16:31]
    ds_read_b64_tr_b16 v[92:93], v7 offset:18432
    ds_read_b64_tr_b16 v[94:95], v7 offset:18944
    s_mov_b32 s88, s16
    v_mfma_f32_32x32x16_bf16 v[32:47], v[108:111], v[136:139], v[32:47]
    v_xor_b32 v162, 32, v162
    ds_read_b128 v[152:155], v162
    s_waitcnt lgkmcnt(11)
    v_mfma_f32_32x32x16_bf16 v[48:63], v[104:107], v[140:143], v[48:63]
    v_xor_b32 v163, 32, v163
    ds_read_b128 v[156:159], v163
    v_mfma_f32_32x32x16_bf16 v[64:79], v[108:111], v[140:143], v[64:79]
    s_waitcnt lgkmcnt(2)
    s_barrier
    v_mfma_f32_32x32x16_bf16 v[16:31], v[80:83], v[144:147], v[16:31]
    ds_read_b64_tr_b16 v[96:97], v6 offset:24576
    ds_read_b64_tr_b16 v[98:99], v6 offset:25088
    v_mfma_f32_32x32x16_bf16 v[32:47], v[84:87], v[144:147], v[32:47]
    v_xor_b32 v162, 96, v162
    ds_read_b128 v[112:115], v162
    ds_read_b64_tr_b16 v[100:101], v7 offset:24576
    v_mfma_f32_32x32x16_bf16 v[48:63], v[80:83], v[148:151], v[48:63]
    ds_read_b64_tr_b16 v[102:103], v7 offset:25088
    ds_read_b64_tr_b16 v[104:105], v6 offset:26624
    ds_read_b64_tr_b16 v[106:107], v6 offset:27136
    v_mfma_f32_32x32x16_bf16 v[64:79], v[84:87], v[148:151], v[64:79]
    v_xor_b32 v163, 96, v163
    ds_read_b128 v[116:119], v163
    s_waitcnt lgkmcnt(9)
    v_mfma_f32_32x32x16_bf16 v[16:31], v[88:91], v[152:155], v[16:31]
    ds_read_b64_tr_b16 v[108:109], v7 offset:26624
    ds_read_b64_tr_b16 v[110:111], v7 offset:27136
    s_mov_b32 s89, s17
    v_mfma_f32_32x32x16_bf16 v[32:47], v[92:95], v[152:155], v[32:47]
    v_xor_b32 v162, 32, v162
    ds_read_b128 v[120:123], v162
    s_waitcnt lgkmcnt(11)
    v_mfma_f32_32x32x16_bf16 v[48:63], v[88:91], v[156:159], v[48:63]
    v_xor_b32 v163, 32, v163
    ds_read_b128 v[124:127], v163
    v_mfma_f32_32x32x16_bf16 v[64:79], v[92:95], v[156:159], v[64:79]
    s_waitcnt lgkmcnt(2)
    s_barrier
    v_mfma_f32_32x32x16_bf16 v[16:31], v[96:99], v[112:115], v[16:31]
    ds_read_b64_tr_b16 v[80:81], v6 offset:0
    ds_read_b64_tr_b16 v[82:83], v6 offset:512
    v_mfma_f32_32x32x16_bf16 v[32:47], v[100:103], v[112:115], v[32:47]
    ds_read_b128 v[128:131], v164
    ds_read_b64_tr_b16 v[84:85], v7 offset:0
    v_mfma_f32_32x32x16_bf16 v[48:63], v[96:99], v[116:119], v[48:63]
    ds_read_b64_tr_b16 v[86:87], v7 offset:512
    ds_read_b64_tr_b16 v[88:89], v6 offset:2048
    ds_read_b64_tr_b16 v[90:91], v6 offset:2560
    v_mfma_f32_32x32x16_bf16 v[64:79], v[100:103], v[116:119], v[64:79]
    ds_read_b128 v[132:135], v165
    s_waitcnt lgkmcnt(9)
    v_mfma_f32_32x32x16_bf16 v[16:31], v[104:107], v[120:123], v[16:31]
    ds_read_b64_tr_b16 v[92:93], v7 offset:2048
    ds_read_b64_tr_b16 v[94:95], v7 offset:2560
    buffer_load_dwordx2 v[188:189], v12, s[88:91], s60 offen offset:0
    v_mfma_f32_32x32x16_bf16 v[32:47], v[108:111], v[120:123], v[32:47]
    v_xor_b32 v164, 32, v164
    ds_read_b128 v[136:139], v164
    s_waitcnt lgkmcnt(11)
    v_mfma_f32_32x32x16_bf16 v[48:63], v[104:107], v[124:127], v[48:63]
    v_xor_b32 v165, 32, v165
    ds_read_b128 v[140:143], v165
    v_mfma_f32_32x32x16_bf16 v[64:79], v[108:111], v[124:127], v[64:79]
    s_waitcnt lgkmcnt(2)
    s_barrier
    v_mfma_f32_32x32x16_bf16 v[16:31], v[80:83], v[128:131], v[16:31]
    ds_read_b64_tr_b16 v[96:97], v6 offset:8192
    ds_read_b64_tr_b16 v[98:99], v6 offset:8704
    v_mfma_f32_32x32x16_bf16 v[32:47], v[84:87], v[128:131], v[32:47]
    v_xor_b32 v164, 96, v164
    ds_read_b128 v[144:147], v164
    ds_read_b64_tr_b16 v[100:101], v7 offset:8192
    v_mfma_f32_32x32x16_bf16 v[48:63], v[80:83], v[132:135], v[48:63]
    ds_read_b64_tr_b16 v[102:103], v7 offset:8704
    ds_read_b64_tr_b16 v[104:105], v6 offset:10240
    ds_read_b64_tr_b16 v[106:107], v6 offset:10752
    v_mfma_f32_32x32x16_bf16 v[64:79], v[84:87], v[132:135], v[64:79]
    v_xor_b32 v165, 96, v165
    ds_read_b128 v[148:151], v165
    s_waitcnt lgkmcnt(9)
    v_mfma_f32_32x32x16_bf16 v[16:31], v[88:91], v[136:139], v[16:31]
    ds_read_b64_tr_b16 v[108:109], v7 offset:10240
    ds_read_b64_tr_b16 v[110:111], v7 offset:10752
    buffer_load_dwordx2 v[190:191], v12, s[88:91], s60 offen offset:16
    v_mfma_f32_32x32x16_bf16 v[32:47], v[92:95], v[136:139], v[32:47]
    v_xor_b32 v164, 32, v164
    ds_read_b128 v[152:155], v164
    s_waitcnt lgkmcnt(11)
    v_mfma_f32_32x32x16_bf16 v[48:63], v[88:91], v[140:143], v[48:63]
    v_xor_b32 v165, 32, v165
    ds_read_b128 v[156:159], v165
    v_mfma_f32_32x32x16_bf16 v[64:79], v[92:95], v[140:143], v[64:79]
    s_waitcnt lgkmcnt(2)
    s_barrier
    v_mfma_f32_32x32x16_bf16 v[16:31], v[96:99], v[144:147], v[16:31]
    ds_read_b64_tr_b16 v[80:81], v6 offset:16384
    ds_read_b64_tr_b16 v[82:83], v6 offset:16896
    v_mfma_f32_32x32x16_bf16 v[32:47], v[100:103], v[144:147], v[32:47]
    ds_read_b128 v[112:115], v166
    ds_read_b64_tr_b16 v[84:85], v7 offset:16384
    v_mfma_f32_32x32x16_bf16 v[48:63], v[96:99], v[148:151], v[48:63]
    ds_read_b64_tr_b16 v[86:87], v7 offset:16896
    ds_read_b64_tr_b16 v[88:89], v6 offset:18432
    ds_read_b64_tr_b16 v[90:91], v6 offset:18944
    v_mfma_f32_32x32x16_bf16 v[64:79], v[100:103], v[148:151], v[64:79]
    ds_read_b128 v[116:119], v167
    s_waitcnt lgkmcnt(9)
    v_mfma_f32_32x32x16_bf16 v[16:31], v[104:107], v[152:155], v[16:31]
    ds_read_b64_tr_b16 v[92:93], v7 offset:18432
    ds_read_b64_tr_b16 v[94:95], v7 offset:18944
    buffer_load_dwordx2 v[192:193], v12, s[88:91], s60 offen offset:32
    v_mfma_f32_32x32x16_bf16 v[32:47], v[108:111], v[152:155], v[32:47]
    v_xor_b32 v166, 32, v166
    ds_read_b128 v[120:123], v166
    s_waitcnt lgkmcnt(11)
    v_mfma_f32_32x32x16_bf16 v[48:63], v[104:107], v[156:159], v[48:63]
    v_xor_b32 v167, 32, v167
    ds_read_b128 v[124:127], v167
    v_mfma_f32_32x32x16_bf16 v[64:79], v[108:111], v[156:159], v[64:79]
    s_waitcnt lgkmcnt(2)
    s_barrier
    v_mfma_f32_32x32x16_bf16 v[16:31], v[80:83], v[112:115], v[16:31]
    ds_read_b64_tr_b16 v[96:97], v6 offset:24576
    ds_read_b64_tr_b16 v[98:99], v6 offset:25088
    v_mfma_f32_32x32x16_bf16 v[32:47], v[84:87], v[112:115], v[32:47]
    v_xor_b32 v166, 96, v166
    ds_read_b128 v[128:131], v166
    ds_read_b64_tr_b16 v[100:101], v7 offset:24576
    v_mfma_f32_32x32x16_bf16 v[48:63], v[80:83], v[116:119], v[48:63]
    ds_read_b64_tr_b16 v[102:103], v7 offset:25088
    ds_read_b64_tr_b16 v[104:105], v6 offset:26624
    ds_read_b64_tr_b16 v[106:107], v6 offset:27136
    v_mfma_f32_32x32x16_bf16 v[64:79], v[84:87], v[116:119], v[64:79]
    v_xor_b32 v167, 96, v167
    ds_read_b128 v[132:135], v167
    s_waitcnt lgkmcnt(9)
    v_mfma_f32_32x32x16_bf16 v[16:31], v[88:91], v[120:123], v[16:31]
    ds_read_b64_tr_b16 v[108:109], v7 offset:26624
    ds_read_b64_tr_b16 v[110:111], v7 offset:27136
    buffer_load_dwordx2 v[194:195], v12, s[88:91], s60 offen offset:48
    v_mfma_f32_32x32x16_bf16 v[32:47], v[92:95], v[120:123], v[32:47]
    v_xor_b32 v166, 32, v166
    ds_read_b128 v[136:139], v166
    s_waitcnt lgkmcnt(11)
    v_mfma_f32_32x32x16_bf16 v[48:63], v[88:91], v[124:127], v[48:63]
    v_xor_b32 v167, 32, v167
    ds_read_b128 v[140:143], v167
    v_mfma_f32_32x32x16_bf16 v[64:79], v[92:95], v[124:127], v[64:79]
    s_waitcnt lgkmcnt(2)
    s_barrier
    v_mfma_f32_32x32x16_bf16 v[16:31], v[96:99], v[128:131], v[16:31]
    ds_read_b64_tr_b16 v[80:81], v6 offset:0
    ds_read_b64_tr_b16 v[82:83], v6 offset:512
    v_mfma_f32_32x32x16_bf16 v[32:47], v[100:103], v[128:131], v[32:47]
    ds_read_b128 v[144:147], v168
    ds_read_b64_tr_b16 v[84:85], v7 offset:0
    v_mfma_f32_32x32x16_bf16 v[48:63], v[96:99], v[132:135], v[48:63]
    ds_read_b64_tr_b16 v[86:87], v7 offset:512
    ds_read_b64_tr_b16 v[88:89], v6 offset:2048
    ds_read_b64_tr_b16 v[90:91], v6 offset:2560
    v_mfma_f32_32x32x16_bf16 v[64:79], v[100:103], v[132:135], v[64:79]
    ds_read_b128 v[148:151], v169
    s_waitcnt lgkmcnt(9)
    v_mfma_f32_32x32x16_bf16 v[16:31], v[104:107], v[136:139], v[16:31]
    ds_read_b64_tr_b16 v[92:93], v7 offset:2048
    ds_read_b64_tr_b16 v[94:95], v7 offset:2560
    buffer_load_dwordx2 v[196:197], v12, s[88:91], s60 offen offset:64
    v_mfma_f32_32x32x16_bf16 v[32:47], v[108:111], v[136:139], v[32:47]
    v_xor_b32 v168, 32, v168
    ds_read_b128 v[152:155], v168
    s_waitcnt lgkmcnt(11)
    v_mfma_f32_32x32x16_bf16 v[48:63], v[104:107], v[140:143], v[48:63]
    v_xor_b32 v169, 32, v169
    ds_read_b128 v[156:159], v169
    v_mfma_f32_32x32x16_bf16 v[64:79], v[108:111], v[140:143], v[64:79]
    s_waitcnt lgkmcnt(2)
    s_barrier
    v_mfma_f32_32x32x16_bf16 v[16:31], v[80:83], v[144:147], v[16:31]
    ds_read_b64_tr_b16 v[96:97], v6 offset:8192
    ds_read_b64_tr_b16 v[98:99], v6 offset:8704
    v_mfma_f32_32x32x16_bf16 v[32:47], v[84:87], v[144:147], v[32:47]
    v_xor_b32 v168, 96, v168
    ds_read_b128 v[112:115], v168
    ds_read_b64_tr_b16 v[100:101], v7 offset:8192
    v_mfma_f32_32x32x16_bf16 v[48:63], v[80:83], v[148:151], v[48:63]
    ds_read_b64_tr_b16 v[102:103], v7 offset:8704
    ds_read_b64_tr_b16 v[104:105], v6 offset:10240
    ds_read_b64_tr_b16 v[106:107], v6 offset:10752
    v_mfma_f32_32x32x16_bf16 v[64:79], v[84:87], v[148:151], v[64:79]
    v_xor_b32 v169, 96, v169
    ds_read_b128 v[116:119], v169
    s_waitcnt lgkmcnt(9)
    v_mfma_f32_32x32x16_bf16 v[16:31], v[88:91], v[152:155], v[16:31]
    ds_read_b64_tr_b16 v[108:109], v7 offset:10240
    ds_read_b64_tr_b16 v[110:111], v7 offset:10752
    buffer_load_dwordx2 v[198:199], v12, s[88:91], s60 offen offset:80
    v_mfma_f32_32x32x16_bf16 v[32:47], v[92:95], v[152:155], v[32:47]
    v_xor_b32 v168, 32, v168
    ds_read_b128 v[120:123], v168
    s_waitcnt lgkmcnt(11)
    v_mfma_f32_32x32x16_bf16 v[48:63], v[88:91], v[156:159], v[48:63]
    v_xor_b32 v169, 32, v169
    ds_read_b128 v[124:127], v169
    v_mfma_f32_32x32x16_bf16 v[64:79], v[92:95], v[156:159], v[64:79]
    s_waitcnt lgkmcnt(2)
    s_barrier
    v_mfma_f32_32x32x16_bf16 v[16:31], v[96:99], v[112:115], v[16:31]
    ds_read_b64_tr_b16 v[80:81], v6 offset:16384
    ds_read_b64_tr_b16 v[82:83], v6 offset:16896
    v_mfma_f32_32x32x16_bf16 v[32:47], v[100:103], v[112:115], v[32:47]
    ds_read_b128 v[128:131], v170
    ds_read_b64_tr_b16 v[84:85], v7 offset:16384
    v_mfma_f32_32x32x16_bf16 v[48:63], v[96:99], v[116:119], v[48:63]
    ds_read_b64_tr_b16 v[86:87], v7 offset:16896
    ds_read_b64_tr_b16 v[88:89], v6 offset:18432
    ds_read_b64_tr_b16 v[90:91], v6 offset:18944
    v_mfma_f32_32x32x16_bf16 v[64:79], v[100:103], v[116:119], v[64:79]
    ds_read_b128 v[132:135], v171
    s_waitcnt lgkmcnt(9)
    v_mfma_f32_32x32x16_bf16 v[16:31], v[104:107], v[120:123], v[16:31]
    ds_read_b64_tr_b16 v[92:93], v7 offset:18432
    ds_read_b64_tr_b16 v[94:95], v7 offset:18944
    buffer_load_dwordx2 v[200:201], v12, s[88:91], s60 offen offset:96
    v_mfma_f32_32x32x16_bf16 v[32:47], v[108:111], v[120:123], v[32:47]
    v_xor_b32 v170, 32, v170
    ds_read_b128 v[136:139], v170
    s_waitcnt lgkmcnt(11)
    v_mfma_f32_32x32x16_bf16 v[48:63], v[104:107], v[124:127], v[48:63]
    v_xor_b32 v171, 32, v171
    ds_read_b128 v[140:143], v171
    v_mfma_f32_32x32x16_bf16 v[64:79], v[108:111], v[124:127], v[64:79]
    s_waitcnt lgkmcnt(2)
    s_barrier
    v_mfma_f32_32x32x16_bf16 v[16:31], v[80:83], v[128:131], v[16:31]
    ds_read_b64_tr_b16 v[96:97], v6 offset:24576
    ds_read_b64_tr_b16 v[98:99], v6 offset:25088
    v_mfma_f32_32x32x16_bf16 v[32:47], v[84:87], v[128:131], v[32:47]
    v_xor_b32 v170, 96, v170
    ds_read_b128 v[144:147], v170
    ds_read_b64_tr_b16 v[100:101], v7 offset:24576
    v_mfma_f32_32x32x16_bf16 v[48:63], v[80:83], v[132:135], v[48:63]
    ds_read_b64_tr_b16 v[102:103], v7 offset:25088
    ds_read_b64_tr_b16 v[104:105], v6 offset:26624
    ds_read_b64_tr_b16 v[106:107], v6 offset:27136
    v_mfma_f32_32x32x16_bf16 v[64:79], v[84:87], v[132:135], v[64:79]
    v_xor_b32 v171, 96, v171
    ds_read_b128 v[148:151], v171
    s_waitcnt lgkmcnt(9)
    v_mfma_f32_32x32x16_bf16 v[16:31], v[88:91], v[136:139], v[16:31]
    ds_read_b64_tr_b16 v[108:109], v7 offset:26624
    ds_read_b64_tr_b16 v[110:111], v7 offset:27136
    buffer_load_dwordx2 v[202:203], v12, s[88:91], s60 offen offset:112
    v_mfma_f32_32x32x16_bf16 v[32:47], v[92:95], v[136:139], v[32:47]
    v_xor_b32 v170, 32, v170
    ds_read_b128 v[152:155], v170
    s_waitcnt lgkmcnt(11)
    v_mfma_f32_32x32x16_bf16 v[48:63], v[88:91], v[140:143], v[48:63]
    v_xor_b32 v171, 32, v171
    ds_read_b128 v[156:159], v171
    v_mfma_f32_32x32x16_bf16 v[64:79], v[92:95], v[140:143], v[64:79]
    s_waitcnt lgkmcnt(2)
    s_barrier
    v_mfma_f32_32x32x16_bf16 v[16:31], v[96:99], v[144:147], v[16:31]
    ds_read_b64_tr_b16 v[80:81], v6 offset:0
    ds_read_b64_tr_b16 v[82:83], v6 offset:512
    v_mfma_f32_32x32x16_bf16 v[32:47], v[100:103], v[144:147], v[32:47]
    ds_read_b128 v[112:115], v172
    ds_read_b64_tr_b16 v[84:85], v7 offset:0
    v_mfma_f32_32x32x16_bf16 v[48:63], v[96:99], v[148:151], v[48:63]
    ds_read_b64_tr_b16 v[86:87], v7 offset:512
    ds_read_b64_tr_b16 v[88:89], v6 offset:2048
    ds_read_b64_tr_b16 v[90:91], v6 offset:2560
    v_mfma_f32_32x32x16_bf16 v[64:79], v[100:103], v[148:151], v[64:79]
    ds_read_b128 v[116:119], v173
    s_waitcnt lgkmcnt(9)
    v_mfma_f32_32x32x16_bf16 v[16:31], v[104:107], v[152:155], v[16:31]
    ds_read_b64_tr_b16 v[92:93], v7 offset:2048
    ds_read_b64_tr_b16 v[94:95], v7 offset:2560
    v_mov_b32 v5, 0
    v_mfma_f32_32x32x16_bf16 v[32:47], v[108:111], v[152:155], v[32:47]
    v_xor_b32 v172, 32, v172
    ds_read_b128 v[120:123], v172
    s_waitcnt lgkmcnt(11)
    v_mfma_f32_32x32x16_bf16 v[48:63], v[104:107], v[156:159], v[48:63]
    v_xor_b32 v173, 32, v173
    ds_read_b128 v[124:127], v173
    v_mfma_f32_32x32x16_bf16 v[64:79], v[108:111], v[156:159], v[64:79]
    s_waitcnt lgkmcnt(2)
    s_barrier
    v_mfma_f32_32x32x16_bf16 v[16:31], v[80:83], v[112:115], v[16:31]
    ds_read_b64_tr_b16 v[96:97], v6 offset:8192
    ds_read_b64_tr_b16 v[98:99], v6 offset:8704
    v_mfma_f32_32x32x16_bf16 v[32:47], v[84:87], v[112:115], v[32:47]
    v_xor_b32 v172, 96, v172
    ds_read_b128 v[128:131], v172
    ds_read_b64_tr_b16 v[100:101], v7 offset:8192
    v_mfma_f32_32x32x16_bf16 v[48:63], v[80:83], v[116:119], v[48:63]
    ds_read_b64_tr_b16 v[102:103], v7 offset:8704
    ds_read_b64_tr_b16 v[104:105], v6 offset:10240
    ds_read_b64_tr_b16 v[106:107], v6 offset:10752
    v_mfma_f32_32x32x16_bf16 v[64:79], v[84:87], v[116:119], v[64:79]
    v_xor_b32 v173, 96, v173
    ds_read_b128 v[132:135], v173
    s_waitcnt lgkmcnt(9)
    v_mfma_f32_32x32x16_bf16 v[16:31], v[88:91], v[120:123], v[16:31]
    ds_read_b64_tr_b16 v[108:109], v7 offset:10240
    ds_read_b64_tr_b16 v[110:111], v7 offset:10752
    global_load_dwordx2 v[2:3], v5, s[22:23] sc1
    v_mfma_f32_32x32x16_bf16 v[32:47], v[92:95], v[120:123], v[32:47]
    v_xor_b32 v172, 32, v172
    ds_read_b128 v[136:139], v172
    s_waitcnt lgkmcnt(11)
    v_mfma_f32_32x32x16_bf16 v[48:63], v[88:91], v[124:127], v[48:63]
    v_xor_b32 v173, 32, v173
    ds_read_b128 v[140:143], v173
    v_mfma_f32_32x32x16_bf16 v[64:79], v[92:95], v[124:127], v[64:79]
    s_waitcnt lgkmcnt(2)
    s_barrier
    v_mfma_f32_32x32x16_bf16 v[16:31], v[96:99], v[128:131], v[16:31]
    ds_read_b64_tr_b16 v[80:81], v6 offset:16384
    ds_read_b64_tr_b16 v[82:83], v6 offset:16896
    v_mfma_f32_32x32x16_bf16 v[32:47], v[100:103], v[128:131], v[32:47]
    ds_read_b128 v[144:147], v174
    ds_read_b64_tr_b16 v[84:85], v7 offset:16384
    v_mfma_f32_32x32x16_bf16 v[48:63], v[96:99], v[132:135], v[48:63]
    ds_read_b64_tr_b16 v[86:87], v7 offset:16896
    ds_read_b64_tr_b16 v[88:89], v6 offset:18432
    ds_read_b64_tr_b16 v[90:91], v6 offset:18944
    v_mfma_f32_32x32x16_bf16 v[64:79], v[100:103], v[132:135], v[64:79]
    ds_read_b128 v[148:151], v175
    s_waitcnt lgkmcnt(9)
    v_mfma_f32_32x32x16_bf16 v[16:31], v[104:107], v[136:139], v[16:31]
    ds_read_b64_tr_b16 v[92:93], v7 offset:18432
    ds_read_b64_tr_b16 v[94:95], v7 offset:18944
    v_mfma_f32_32x32x16_bf16 v[32:47], v[108:111], v[136:139], v[32:47]
    v_xor_b32 v174, 32, v174
    ds_read_b128 v[152:155], v174
    s_waitcnt lgkmcnt(11)
    v_mfma_f32_32x32x16_bf16 v[48:63], v[104:107], v[140:143], v[48:63]
    v_xor_b32 v175, 32, v175
    ds_read_b128 v[156:159], v175
    v_mfma_f32_32x32x16_bf16 v[64:79], v[108:111], v[140:143], v[64:79]
    s_waitcnt lgkmcnt(2)
    s_barrier
    v_mfma_f32_32x32x16_bf16 v[16:31], v[80:83], v[144:147], v[16:31]
    ds_read_b64_tr_b16 v[96:97], v6 offset:24576
    ds_read_b64_tr_b16 v[98:99], v6 offset:25088
    v_mfma_f32_32x32x16_bf16 v[32:47], v[84:87], v[144:147], v[32:47]
    v_xor_b32 v174, 96, v174
    ds_read_b128 v[112:115], v174
    ds_read_b64_tr_b16 v[100:101], v7 offset:24576
    v_mfma_f32_32x32x16_bf16 v[48:63], v[80:83], v[148:151], v[48:63]
    ds_read_b64_tr_b16 v[102:103], v7 offset:25088
    ds_read_b64_tr_b16 v[104:105], v6 offset:26624
    ds_read_b64_tr_b16 v[106:107], v6 offset:27136
    v_mfma_f32_32x32x16_bf16 v[64:79], v[84:87], v[148:151], v[64:79]
    v_xor_b32 v175, 96, v175
    ds_read_b128 v[116:119], v175
    s_waitcnt lgkmcnt(9)
    v_mfma_f32_32x32x16_bf16 v[16:31], v[88:91], v[152:155], v[16:31]
    ds_read_b64_tr_b16 v[108:109], v7 offset:26624
    ds_read_b64_tr_b16 v[110:111], v7 offset:27136
    v_mfma_f32_32x32x16_bf16 v[32:47], v[92:95], v[152:155], v[32:47]
    v_xor_b32 v174, 32, v174
    ds_read_b128 v[120:123], v174
    s_waitcnt lgkmcnt(11)
    v_mfma_f32_32x32x16_bf16 v[48:63], v[88:91], v[156:159], v[48:63]
    v_xor_b32 v175, 32, v175
    ds_read_b128 v[124:127], v175
    v_mfma_f32_32x32x16_bf16 v[64:79], v[92:95], v[156:159], v[64:79]
    s_waitcnt lgkmcnt(2)
    s_barrier
    v_mfma_f32_32x32x16_bf16 v[16:31], v[96:99], v[112:115], v[16:31]
    ds_read_b64_tr_b16 v[80:81], v6 offset:0
    ds_read_b64_tr_b16 v[82:83], v6 offset:512
    v_mfma_f32_32x32x16_bf16 v[32:47], v[100:103], v[112:115], v[32:47]
    ds_read_b128 v[128:131], v176
    ds_read_b64_tr_b16 v[84:85], v7 offset:0
    v_mfma_f32_32x32x16_bf16 v[48:63], v[96:99], v[116:119], v[48:63]
    ds_read_b64_tr_b16 v[86:87], v7 offset:512
    ds_read_b64_tr_b16 v[88:89], v6 offset:2048
    ds_read_b64_tr_b16 v[90:91], v6 offset:2560
    v_mfma_f32_32x32x16_bf16 v[64:79], v[100:103], v[116:119], v[64:79]
    ds_read_b128 v[132:135], v177
    s_waitcnt lgkmcnt(9)
    v_mfma_f32_32x32x16_bf16 v[16:31], v[104:107], v[120:123], v[16:31]
    ds_read_b64_tr_b16 v[92:93], v7 offset:2048
    ds_read_b64_tr_b16 v[94:95], v7 offset:2560
    v_mfma_f32_32x32x16_bf16 v[32:47], v[108:111], v[120:123], v[32:47]
    v_xor_b32 v176, 32, v176
    ds_read_b128 v[136:139], v176
    s_waitcnt lgkmcnt(11)
    v_mfma_f32_32x32x16_bf16 v[48:63], v[104:107], v[124:127], v[48:63]
    v_xor_b32 v177, 32, v177
    ds_read_b128 v[140:143], v177
    v_mfma_f32_32x32x16_bf16 v[64:79], v[108:111], v[124:127], v[64:79]
    s_waitcnt lgkmcnt(2)
    s_barrier
    v_mfma_f32_32x32x16_bf16 v[16:31], v[80:83], v[128:131], v[16:31]
    ds_read_b64_tr_b16 v[96:97], v6 offset:8192
    ds_read_b64_tr_b16 v[98:99], v6 offset:8704
    v_mfma_f32_32x32x16_bf16 v[32:47], v[84:87], v[128:131], v[32:47]
    v_xor_b32 v176, 96, v176
    ds_read_b128 v[144:147], v176
    ds_read_b64_tr_b16 v[100:101], v7 offset:8192
    v_mfma_f32_32x32x16_bf16 v[48:63], v[80:83], v[132:135], v[48:63]
    ds_read_b64_tr_b16 v[102:103], v7 offset:8704
    ds_read_b64_tr_b16 v[104:105], v6 offset:10240
    ds_read_b64_tr_b16 v[106:107], v6 offset:10752
    v_mfma_f32_32x32x16_bf16 v[64:79], v[84:87], v[132:135], v[64:79]
    v_xor_b32 v177, 96, v177
    ds_read_b128 v[148:151], v177
    s_waitcnt lgkmcnt(9)
    v_mfma_f32_32x32x16_bf16 v[16:31], v[88:91], v[136:139], v[16:31]
    ds_read_b64_tr_b16 v[108:109], v7 offset:10240
    ds_read_b64_tr_b16 v[110:111], v7 offset:10752
    v_mfma_f32_32x32x16_bf16 v[32:47], v[92:95], v[136:139], v[32:47]
    v_xor_b32 v176, 32, v176
    ds_read_b128 v[152:155], v176
    s_waitcnt lgkmcnt(11)
    v_mfma_f32_32x32x16_bf16 v[48:63], v[88:91], v[140:143], v[48:63]
    v_xor_b32 v177, 32, v177
    ds_read_b128 v[156:159], v177
    v_mfma_f32_32x32x16_bf16 v[64:79], v[92:95], v[140:143], v[64:79]
    s_waitcnt lgkmcnt(2)
    s_barrier
    v_mfma_f32_32x32x16_bf16 v[16:31], v[96:99], v[144:147], v[16:31]
    ds_read_b64_tr_b16 v[80:81], v6 offset:16384
    ds_read_b64_tr_b16 v[82:83], v6 offset:16896
    v_mfma_f32_32x32x16_bf16 v[32:47], v[100:103], v[144:147], v[32:47]
    ds_read_b128 v[112:115], v178
    ds_read_b64_tr_b16 v[84:85], v7 offset:16384
    v_mfma_f32_32x32x16_bf16 v[48:63], v[96:99], v[148:151], v[48:63]
    ds_read_b64_tr_b16 v[86:87], v7 offset:16896
    ds_read_b64_tr_b16 v[88:89], v6 offset:18432
    ds_read_b64_tr_b16 v[90:91], v6 offset:18944
    v_mfma_f32_32x32x16_bf16 v[64:79], v[100:103], v[148:151], v[64:79]
    ds_read_b128 v[116:119], v179
    s_waitcnt lgkmcnt(9)
    v_mfma_f32_32x32x16_bf16 v[16:31], v[104:107], v[152:155], v[16:31]
    ds_read_b64_tr_b16 v[92:93], v7 offset:18432
    ds_read_b64_tr_b16 v[94:95], v7 offset:18944
    v_mfma_f32_32x32x16_bf16 v[32:47], v[108:111], v[152:155], v[32:47]
    v_xor_b32 v178, 32, v178
    ds_read_b128 v[120:123], v178
    s_waitcnt lgkmcnt(11)
    v_mfma_f32_32x32x16_bf16 v[48:63], v[104:107], v[156:159], v[48:63]
    v_xor_b32 v179, 32, v179
    ds_read_b128 v[124:127], v179
    v_mfma_f32_32x32x16_bf16 v[64:79], v[108:111], v[156:159], v[64:79]
    s_waitcnt lgkmcnt(2)
    s_barrier
    v_mfma_f32_32x32x16_bf16 v[16:31], v[80:83], v[112:115], v[16:31]
    ds_read_b64_tr_b16 v[96:97], v6 offset:24576
    ds_read_b64_tr_b16 v[98:99], v6 offset:25088
    v_mfma_f32_32x32x16_bf16 v[32:47], v[84:87], v[112:115], v[32:47]
    v_xor_b32 v178, 96, v178
    ds_read_b128 v[128:131], v178
    ds_read_b64_tr_b16 v[100:101], v7 offset:24576
    v_mfma_f32_32x32x16_bf16 v[48:63], v[80:83], v[116:119], v[48:63]
    ds_read_b64_tr_b16 v[102:103], v7 offset:25088
    ds_read_b64_tr_b16 v[104:105], v6 offset:26624
    ds_read_b64_tr_b16 v[106:107], v6 offset:27136
    v_mfma_f32_32x32x16_bf16 v[64:79], v[84:87], v[116:119], v[64:79]
    v_xor_b32 v179, 96, v179
    ds_read_b128 v[132:135], v179
    s_waitcnt lgkmcnt(9)
    v_mfma_f32_32x32x16_bf16 v[16:31], v[88:91], v[120:123], v[16:31]
    ds_read_b64_tr_b16 v[108:109], v7 offset:26624
    ds_read_b64_tr_b16 v[110:111], v7 offset:27136
    v_mfma_f32_32x32x16_bf16 v[32:47], v[92:95], v[120:123], v[32:47]
    v_xor_b32 v178, 32, v178
    ds_read_b128 v[136:139], v178
    s_waitcnt lgkmcnt(11)
    v_mfma_f32_32x32x16_bf16 v[48:63], v[88:91], v[124:127], v[48:63]
    v_xor_b32 v179, 32, v179
    ds_read_b128 v[140:143], v179
    v_mfma_f32_32x32x16_bf16 v[64:79], v[92:95], v[124:127], v[64:79]
    s_waitcnt lgkmcnt(2)
    s_barrier
    v_mfma_f32_32x32x16_bf16 v[16:31], v[96:99], v[128:131], v[16:31]
    ds_read_b64_tr_b16 v[80:81], v6 offset:0
    ds_read_b64_tr_b16 v[82:83], v6 offset:512
    v_mfma_f32_32x32x16_bf16 v[32:47], v[100:103], v[128:131], v[32:47]
    ds_read_b128 v[144:147], v180
    ds_read_b64_tr_b16 v[84:85], v7 offset:0
    v_mfma_f32_32x32x16_bf16 v[48:63], v[96:99], v[132:135], v[48:63]
    ds_read_b64_tr_b16 v[86:87], v7 offset:512
    ds_read_b64_tr_b16 v[88:89], v6 offset:2048
    ds_read_b64_tr_b16 v[90:91], v6 offset:2560
    v_mfma_f32_32x32x16_bf16 v[64:79], v[100:103], v[132:135], v[64:79]
    ds_read_b128 v[148:151], v181
    s_waitcnt lgkmcnt(9)
    v_mfma_f32_32x32x16_bf16 v[16:31], v[104:107], v[136:139], v[16:31]
    ds_read_b64_tr_b16 v[92:93], v7 offset:2048
    ds_read_b64_tr_b16 v[94:95], v7 offset:2560
    v_mfma_f32_32x32x16_bf16 v[32:47], v[108:111], v[136:139], v[32:47]
    v_xor_b32 v180, 32, v180
    ds_read_b128 v[152:155], v180
    s_waitcnt lgkmcnt(11)
    v_mfma_f32_32x32x16_bf16 v[48:63], v[104:107], v[140:143], v[48:63]
    v_xor_b32 v181, 32, v181
    ds_read_b128 v[156:159], v181
    v_mfma_f32_32x32x16_bf16 v[64:79], v[108:111], v[140:143], v[64:79]
    s_waitcnt lgkmcnt(2)
    s_barrier
    v_mfma_f32_32x32x16_bf16 v[16:31], v[80:83], v[144:147], v[16:31]
    ds_read_b64_tr_b16 v[96:97], v6 offset:8192
    ds_read_b64_tr_b16 v[98:99], v6 offset:8704
    v_mfma_f32_32x32x16_bf16 v[32:47], v[84:87], v[144:147], v[32:47]
    v_xor_b32 v180, 96, v180
    ds_read_b128 v[112:115], v180
    ds_read_b64_tr_b16 v[100:101], v7 offset:8192
    v_mfma_f32_32x32x16_bf16 v[48:63], v[80:83], v[148:151], v[48:63]
    ds_read_b64_tr_b16 v[102:103], v7 offset:8704
    ds_read_b64_tr_b16 v[104:105], v6 offset:10240
    ds_read_b64_tr_b16 v[106:107], v6 offset:10752
    v_mfma_f32_32x32x16_bf16 v[64:79], v[84:87], v[148:151], v[64:79]
    v_xor_b32 v181, 96, v181
    ds_read_b128 v[116:119], v181
    s_waitcnt lgkmcnt(9)
    v_mfma_f32_32x32x16_bf16 v[16:31], v[88:91], v[152:155], v[16:31]
    ds_read_b64_tr_b16 v[108:109], v7 offset:10240
    ds_read_b64_tr_b16 v[110:111], v7 offset:10752
L_dtag:
    s_waitcnt vmcnt(0)
    v_readfirstlane_b32 s58, v2
    v_readfirstlane_b32 s27, v3
    s_cmp_eq_u32 s58, 0
    s_cbranch_scc1 L_dslow
    v_mfma_f32_32x32x16_bf16 v[32:47], v[92:95], v[152:155], v[32:47]
    v_xor_b32 v180, 32, v180
    ds_read_b128 v[120:123], v180
    s_waitcnt lgkmcnt(11)
    v_mfma_f32_32x32x16_bf16 v[48:63], v[88:91], v[156:159], v[48:63]
    v_xor_b32 v181, 32, v181
    ds_read_b128 v[124:127], v181
    v_mfma_f32_32x32x16_bf16 v[64:79], v[92:95], v[156:159], v[64:79]
    s_waitcnt lgkmcnt(2)
    s_barrier
    v_mfma_f32_32x32x16_bf16 v[16:31], v[96:99], v[112:115], v[16:31]
    ds_read_b64_tr_b16 v[80:81], v6 offset:16384
    ds_read_b64_tr_b16 v[82:83], v6 offset:16896
    v_mfma_f32_32x32x16_bf16 v[32:47], v[100:103], v[112:115], v[32:47]
    ds_read_b128 v[128:131], v182
    ds_read_b64_tr_b16 v[84:85], v7 offset:16384
    v_mfma_f32_32x32x16_bf16 v[48:63], v[96:99], v[116:119], v[48:63]
    ds_read_b64_tr_b16 v[86:87], v7 offset:16896
    ds_read_b64_tr_b16 v[88:89], v6 offset:18432
    ds_read_b64_tr_b16 v[90:91], v6 offset:18944
    v_mfma_f32_32x32x16_bf16 v[64:79], v[100:103], v[116:119], v[64:79]
    ds_read_b128 v[132:135], v183
    s_waitcnt lgkmcnt(9)
    v_mfma_f32_32x32x16_bf16 v[16:31], v[104:107], v[120:123], v[16:31]
    ds_read_b64_tr_b16 v[92:93], v7 offset:18432
    ds_read_b64_tr_b16 v[94:95], v7 offset:18944
    s_mov_b32 s60, 0xbdd2d3e8
    v_mov_b32 v9, 0xc0135761
    s_lshl_b32 s58, s40, 8
    s_add_u32 s58, s58, 128000
    v_mfma_f32_32x32x16_bf16 v[32:47], v[108:111], v[120:123], v[32:47]
    v_xor_b32 v182, 32, v182
    ds_read_b128 v[136:139], v182
    s_waitcnt lgkmcnt(11)
    v_mfma_f32_32x32x16_bf16 v[48:63], v[104:107], v[124:127], v[48:63]
    v_xor_b32 v183, 32, v183
    ds_read_b128 v[140:143], v183
    v_mfma_f32_32x32x16_bf16 v[64:79], v[108:111], v[124:127], v[64:79]
    s_waitcnt lgkmcnt(2)
    s_barrier
    v_mfma_f32_32x32x16_bf16 v[16:31], v[80:83], v[128:131], v[16:31]
    ds_read_b64_tr_b16 v[96:97], v6 offset:24576
    ds_read_b64_tr_b16 v[98:99], v6 offset:25088
    v_mfma_f32_32x32x16_bf16 v[32:47], v[84:87], v[128:131], v[32:47]
    v_xor_b32 v182, 96, v182
    ds_read_b128 v[144:147], v182
    ds_read_b64_tr_b16 v[100:101], v7 offset:24576
    v_mfma_f32_32x32x16_bf16 v[48:63], v[80:83], v[132:135], v[48:63]
    ds_read_b64_tr_b16 v[102:103], v7 offset:25088
    ds_read_b64_tr_b16 v[104:105], v6 offset:26624
    ds_read_b64_tr_b16 v[106:107], v6 offset:27136
    v_mfma_f32_32x32x16_bf16 v[64:79], v[84:87], v[132:135], v[64:79]
    v_xor_b32 v183, 96, v183
    ds_read_b128 v[148:151], v183
    s_waitcnt lgkmcnt(9)
    v_mfma_f32_32x32x16_bf16 v[16:31], v[88:91], v[136:139], v[16:31]
    ds_read_b64_tr_b16 v[108:109], v7 offset:26624
    ds_read_b64_tr_b16 v[110:111], v7 offset:27136
    v_lshl_add_u32 v10, v1, 2, s58
    v_xor_b32 v11, 512, v10
    v_mov_b32 v13, 100
    v_mfma_f32_32x32x16_bf16 v[32:47], v[92:95], v[136:139], v[32:47]
    v_xor_b32 v182, 32, v182
    ds_read_b128 v[152:155], v182
    s_waitcnt lgkmcnt(11)
    v_mfma_f32_32x32x16_bf16 v[48:63], v[88:91], v[140:143], v[48:63]
    v_xor_b32 v183, 32, v183
    ds_read_b128 v[156:159], v183
    v_mfma_f32_32x32x16_bf16 v[64:79], v[92:95], v[140:143], v[64:79]
    s_waitcnt lgkmcnt(2)
    s_barrier
    v_mfma_f32_32x32x16_bf16 v[16:31], v[96:99], v[144:147], v[16:31]
    ds_read_b64_tr_b16 v[80:81], v6 offset:0
    ds_read_b64_tr_b16 v[82:83], v6 offset:512
    v_mfma_f32_32x32x16_bf16 v[32:47], v[100:103], v[144:147], v[32:47]
    ds_read_b128 v[112:115], v184
    ds_read_b64_tr_b16 v[84:85], v7 offset:0
    v_mfma_f32_32x32x16_bf16 v[48:63], v[96:99], v[148:151], v[48:63]
    ds_read_b64_tr_b16 v[86:87], v7 offset:512
    ds_read_b64_tr_b16 v[88:89], v6 offset:2048
    ds_read_b64_tr_b16 v[90:91], v6 offset:2560
    v_mfma_f32_32x32x16_bf16 v[64:79], v[100:103], v[148:151], v[64:79]
    ds_read_b128 v[116:119], v185
    s_waitcnt lgkmcnt(9)
    v_mfma_f32_32x32x16_bf16 v[16:31], v[104:107], v[152:155], v[16:31]
    ds_read_b64_tr_b16 v[92:93], v7 offset:2048
    ds_read_b64_tr_b16 v[94:95], v7 offset:2560
    v_mfma_f32_32x32x16_bf16 v[32:47], v[108:111], v[152:155], v[32:47]
    v_xor_b32 v184, 32, v184
    ds_read_b128 v[120:123], v184
    s_waitcnt lgkmcnt(11)
    v_mfma_f32_32x32x16_bf16 v[48:63], v[104:107], v[156:159], v[48:63]
    v_xor_b32 v185, 32, v185
    ds_read_b128 v[124:127], v185
    v_mfma_f32_32x32x16_bf16 v[64:79], v[108:111], v[156:159], v[64:79]
    s_waitcnt lgkmcnt(2)
    s_barrier
    v_mfma_f32_32x32x16_bf16 v[16:31], v[80:83], v[112:115], v[16:31]
    ds_read_b64_tr_b16 v[96:97], v6 offset:8192
    ds_read_b64_tr_b16 v[98:99], v6 offset:8704
    v_mfma_f32_32x32x16_bf16 v[32:47], v[84:87], v[112:115], v[32:47]
    v_xor_b32 v184, 96, v184
    ds_read_b128 v[128:131], v184
    ds_read_b64_tr_b16 v[100:101], v7 offset:8192
    v_mfma_f32_32x32x16_bf16 v[48:63], v[80:83], v[116:119], v[48:63]
    ds_read_b64_tr_b16 v[102:103], v7 offset:8704
    ds_read_b64_tr_b16 v[104:105], v6 offset:10240
    ds_read_b64_tr_b16 v[106:107], v6 offset:10752
    v_mfma_f32_32x32x16_bf16 v[64:79], v[84:87], v[116:119], v[64:79]
    v_xor_b32 v185, 96, v185
    ds_read_b128 v[132:135], v185
    s_waitcnt lgkmcnt(9)
    v_mfma_f32_32x32x16_bf16 v[16:31], v[88:91], v[120:123], v[16:31]
    ds_read_b64_tr_b16 v[108:109], v7 offset:10240
    ds_read_b64_tr_b16 v[110:111], v7 offset:10752
    v_mfma_f32_32x32x16_bf16 v[32:47], v[92:95], v[120:123], v[32:47]
    v_xor_b32 v184, 32, v184
    ds_read_b128 v[136:139], v184
    s_waitcnt lgkmcnt(11)
    v_mfma_f32_32x32x16_bf16 v[48:63], v[88:91], v[124:127], v[48:63]
    v_xor_b32 v185, 32, v185
    ds_read_b128 v[140:143], v185
    v_mfma_f32_32x32x16_bf16 v[64:79], v[92:95], v[124:127], v[64:79]
    s_waitcnt lgkmcnt(2)
    s_barrier
    v_mfma_f32_32x32x16_bf16 v[48:63], v[96:99], v[132:135], v[48:63]
    s_waitcnt lgkmcnt(0)
    v_mfma_f32_32x32x16_bf16 v[48:63], v[104:107], v[140:143], v[48:63]
    v_mfma_f32_32x32x16_bf16 v[64:79], v[100:103], v[132:135], v[64:79]
    v_mfma_f32_32x32x16_bf16 v[64:79], v[108:111], v[140:143], v[64:79]
    v_mfma_f32_32x32x16_bf16 v[16:31], v[96:99], v[128:131], v[16:31]
    s_nop 8
    ds_write_b128 v187, v[48:51] offset:0
    v_mfma_f32_32x32x16_bf16 v[32:47], v[100:103], v[128:131], v[32:47]
    ds_write_b128 v187, v[52:55] offset:1024
    v_mfma_f32_32x32x16_bf16 v[16:31], v[104:107], v[136:139], v[16:31]
    ds_write_b128 v187, v[56:59] offset:2048
    v_mfma_f32_32x32x16_bf16 v[32:47], v[108:111], v[136:139], v[32:47]
    ds_write_b128 v187, v[60:63] offset:3072
    s_waitcnt lgkmcnt(0)
    s_barrier
    ds_read_b128 v[80:83], v186 offset:0
    ds_read_b128 v[84:87], v186 offset:1024
    ds_read_b128 v[88:91], v186 offset:2048
    ds_read_b128 v[92:95], v186 offset:3072
    ds_write_b128 v15, v[64:67] offset:4096
    ds_write_b128 v15, v[68:71] offset:5120
    ds_write_b128 v15, v[72:75] offset:6144
    ds_write_b128 v15, v[76:79] offset:7168
    s_waitcnt lgkmcnt(7)
    v_add_f32 v16, v16, v80
    v_add_f32 v17, v17, v81
    v_add_f32 v18, v18, v82
    v_add_f32 v19, v19, v83
    v_mul_f32 v112, v16, v16
    v_mul_f32 v113, v17, v17
    v_mul_f32 v114, v18, v18
    v_mul_f32 v115, v19, v19
    v_fma_f32 v112, v112, s60, v9
    v_fma_f32 v113, v113, s60, v9
    v_fma_f32 v114, v114, s60, v9
    v_fma_f32 v115, v115, s60, v9
    v_mul_f32 v112, v112, v16
    v_mul_f32 v113, v113, v17
    v_mul_f32 v114, v114, v18
    v_mul_f32 v115, v115, v19
    v_exp_f32 v112, v112
    v_exp_f32 v113, v113
    v_exp_f32 v114, v114
    v_exp_f32 v115, v115
    v_add_f32 v112, 1.0, v112
    v_add_f32 v113, 1.0, v113
    v_add_f32 v114, 1.0, v114
    v_add_f32 v115, 1.0, v115
    v_rcp_f32 v112, v112
    v_rcp_f32 v113, v113
    v_rcp_f32 v114, v114
    v_rcp_f32 v115, v115
    v_mul_f32 v16, v16, v112
    v_mul_f32 v17, v17, v113
    v_mul_f32 v18, v18, v114
    v_mul_f32 v19, v19, v115
    v_cvt_pk_bf16_f32 v16, v16, v17
    v_cvt_pk_bf16_f32 v17, v18, v19
    s_waitcnt lgkmcnt(0)
    ds_write_b32 v10, v13
    v_add_f32 v20, v20, v84
    v_add_f32 v21, v21, v85
    v_add_f32 v22, v22, v86
    v_add_f32 v23, v23, v87
    v_mul_f32 v116, v20, v20
    v_mul_f32 v117, v21, v21
    v_mul_f32 v118, v22, v22
    v_mul_f32 v119, v23, v23
    v_fma_f32 v116, v116, s60, v9
    v_fma_f32 v117, v117, s60, v9
    v_fma_f32 v118, v118, s60, v9
    v_fma_f32 v119, v119, s60, v9
    v_mul_f32 v116, v116, v20
    v_mul_f32 v117, v117, v21
    v_mul_f32 v118, v118, v22
    v_mul_f32 v119, v119, v23
    v_exp_f32 v116, v116
    v_exp_f32 v117, v117
    v_exp_f32 v118, v118
    v_exp_f32 v119, v119
    v_add_f32 v116, 1.0, v116
    v_add_f32 v117, 1.0, v117
    v_add_f32 v118, 1.0, v118
    v_add_f32 v119, 1.0, v119
    v_rcp_f32 v116, v116
    v_rcp_f32 v117, v117
    v_rcp_f32 v118, v118
    v_rcp_f32 v119, v119
    v_mul_f32 v20, v20, v116
    v_mul_f32 v21, v21, v117
    v_mul_f32 v22, v22, v118
    v_mul_f32 v23, v23, v119
    v_cvt_pk_bf16_f32 v18, v20, v21
    v_cvt_pk_bf16_f32 v19, v22, v23
    s_nop 1
    v_mfma_f32_32x32x16_bf16 v[128:143], v[188:191], v[16:19], 0
L_xchk:
    ds_read_b32 v12, v11
    s_waitcnt lgkmcnt(0)
    v_cmp_ne_u32 vcc, v12, v13
    s_cbranch_vccnz L_xslow
    ds_read_b128 v[96:99], v14 offset:4096
    ds_read_b128 v[100:103], v14 offset:5120
    ds_read_b128 v[104:107], v14 offset:6144
    ds_read_b128 v[108:111], v14 offset:7168
    v_add_f32 v24, v24, v88
    v_add_f32 v25, v25, v89
    v_add_f32 v26, v26, v90
    v_add_f32 v27, v27, v91
    v_mul_f32 v112, v24, v24
    v_mul_f32 v113, v25, v25
    v_mul_f32 v114, v26, v26
    v_mul_f32 v115, v27, v27
    v_fma_f32 v112, v112, s60, v9
    v_fma_f32 v113, v113, s60, v9
    v_fma_f32 v114, v114, s60, v9
    v_fma_f32 v115, v115, s60, v9
    v_mul_f32 v112, v112, v24
    v_mul_f32 v113, v113, v25
    v_mul_f32 v114, v114, v26
    v_mul_f32 v115, v115, v27
    v_exp_f32 v112, v112
    v_exp_f32 v113, v113
    v_exp_f32 v114, v114
    v_exp_f32 v115, v115
    v_add_f32 v112, 1.0, v112
    v_add_f32 v113, 1.0, v113
    v_add_f32 v114, 1.0, v114
    v_add_f32 v115, 1.0, v115
    v_rcp_f32 v112, v112
    v_rcp_f32 v113, v113
    v_rcp_f32 v114, v114
    v_rcp_f32 v115, v115
    v_mul_f32 v24, v24, v112
    v_mul_f32 v25, v25, v113
    v_mul_f32 v26, v26, v114
    v_mul_f32 v27, v27, v115
    v_cvt_pk_bf16_f32 v20, v24, v25
    v_cvt_pk_bf16_f32 v21, v26, v27
    v_add_f32 v28, v28, v92
    v_add_f32 v29, v29, v93
    v_add_f32 v30, v30, v94
    v_add_f32 v31, v31, v95
    v_mul_f32 v116, v28, v28
    v_mul_f32 v117, v29, v29
    v_mul_f32 v118, v30, v30
    v_mul_f32 v119, v31, v31
    v_fma_f32 v116, v116, s60, v9
    v_fma_f32 v117, v117, s60, v9
    v_fma_f32 v118, v118, s60, v9
    v_fma_f32 v119, v119, s60, v9
    v_mul_f32 v116, v116, v28
    v_mul_f32 v117, v117, v29
    v_mul_f32 v118, v118, v30
    v_mul_f32 v119, v119, v31
    v_exp_f32 v116, v116
    v_exp_f32 v117, v117
    v_exp_f32 v118, v118
    v_exp_f32 v119, v119
    v_add_f32 v116, 1.0, v116
    v_add_f32 v117, 1.0, v117
    v_add_f32 v118, 1.0, v118
    v_add_f32 v119, 1.0, v119
    v_rcp_f32 v116, v116
    v_rcp_f32 v117, v117
    v_rcp_f32 v118, v118
    v_rcp_f32 v119, v119
    v_mul_f32 v28, v28, v116
    v_mul_f32 v29, v29, v117
    v_mul_f32 v30, v30, v118
    v_mul_f32 v31, v31, v119
    v_cvt_pk_bf16_f32 v22, v28, v29
    v_cvt_pk_bf16_f32 v23, v30, v31
    s_nop 1
    v_mfma_f32_32x32x16_bf16 v[128:143], v[192:195], v[20:23], v[128:143]
    s_waitcnt lgkmcnt(3)
    v_add_f32 v32, v32, v96
    v_add_f32 v33, v33, v97
    v_add_f32 v34, v34, v98
    v_add_f32 v35, v35, v99
    v_mul_f32 v112, v32, v32
    v_mul_f32 v113, v33, v33
    v_mul_f32 v114, v34, v34
    v_mul_f32 v115, v35, v35
    v_fma_f32 v112, v112, s60, v9
    v_fma_f32 v113, v113, s60, v9
    v_fma_f32 v114, v114, s60, v9
    v_fma_f32 v115, v115, s60, v9
    v_mul_f32 v112, v112, v32
    v_mul_f32 v113, v113, v33
    v_mul_f32 v114, v114, v34
    v_mul_f32 v115, v115, v35
    v_exp_f32 v112, v112
    v_exp_f32 v113, v113
    v_exp_f32 v114, v114
    v_exp_f32 v115, v115
    v_add_f32 v112, 1.0, v112
    v_add_f32 v113, 1.0, v113
    v_add_f32 v114, 1.0, v114
    v_add_f32 v115, 1.0, v115
    v_rcp_f32 v112, v112
    v_rcp_f32 v113, v113
    v_rcp_f32 v114, v114
    v_rcp_f32 v115, v115
    v_mul_f32 v32, v32, v112
    v_mul_f32 v33, v33, v113
    v_mul_f32 v34, v34, v114
    v_mul_f32 v35, v35, v115
    v_cvt_pk_bf16_f32 v24, v32, v33
    v_cvt_pk_bf16_f32 v25, v34, v35
    s_waitcnt lgkmcnt(2)
    v_add_f32 v36, v36, v100
    v_add_f32 v37, v37, v101
    v_add_f32 v38, v38, v102
    v_add_f32 v39, v39, v103
    v_mul_f32 v116, v36, v36
    v_mul_f32 v117, v37, v37
    v_mul_f32 v118, v38, v38
    v_mul_f32 v119, v39, v39
    v_fma_f32 v116, v116, s60, v9
    v_fma_f32 v117, v117, s60, v9
    v_fma_f32 v118, v118, s60, v9
    v_fma_f32 v119, v119, s60, v9
    v_mul_f32 v116, v116, v36
    v_mul_f32 v117, v117, v37
    v_mul_f32 v118, v118, v38
    v_mul_f32 v119, v119, v39
    v_exp_f32 v116, v116
    v_exp_f32 v117, v117
    v_exp_f32 v118, v118
    v_exp_f32 v119, v119
    v_add_f32 v116, 1.0, v116
    v_add_f32 v117, 1.0, v117
    v_add_f32 v118, 1.0, v118
    v_add_f32 v119, 1.0, v119
    v_rcp_f32 v116, v116
    v_rcp_f32 v117, v117
    v_rcp_f32 v118, v118
    v_rcp_f32 v119, v119
    v_mul_f32 v36, v36, v116
    v_mul_f32 v37, v37, v117
    v_mul_f32 v38, v38, v118
    v_mul_f32 v39, v39, v119
    v_cvt_pk_bf16_f32 v26, v36, v37
    v_cvt_pk_bf16_f32 v27, v38, v39
    s_nop 1
    v_mfma_f32_32x32x16_bf16 v[128:143], v[196:199], v[24:27], v[128:143]
    s_waitcnt lgkmcnt(1)
    v_add_f32 v40, v40, v104
    v_add_f32 v41, v41, v105
    v_add_f32 v42, v42, v106
    v_add_f32 v43, v43, v107
    v_mul_f32 v112, v40, v40
    v_mul_f32 v113, v41, v41
    v_mul_f32 v114, v42, v42
    v_mul_f32 v115, v43, v43
    v_fma_f32 v112, v112, s60, v9
    v_fma_f32 v113, v113, s60, v9
    v_fma_f32 v114, v114, s60, v9
    v_fma_f32 v115, v115, s60, v9
    v_mul_f32 v112, v112, v40
    v_mul_f32 v113, v113, v41
    v_mul_f32 v114, v114, v42
    v_mul_f32 v115, v115, v43
    v_exp_f32 v112, v112
    v_exp_f32 v113, v113
    v_exp_f32 v114, v114
    v_exp_f32 v115, v115
    v_add_f32 v112, 1.0, v112
    v_add_f32 v113, 1.0, v113
    v_add_f32 v114, 1.0, v114
    v_add_f32 v115, 1.0, v115
    v_rcp_f32 v112, v112
    v_rcp_f32 v113, v113
    v_rcp_f32 v114, v114
    v_rcp_f32 v115, v115
    v_mul_f32 v40, v40, v112
    v_mul_f32 v41, v41, v113
    v_mul_f32 v42, v42, v114
    v_mul_f32 v43, v43, v115
    v_cvt_pk_bf16_f32 v28, v40, v41
    v_cvt_pk_bf16_f32 v29, v42, v43
    s_waitcnt lgkmcnt(0)
    v_add_f32 v44, v44, v108
    v_add_f32 v45, v45, v109
    v_add_f32 v46, v46, v110
    v_add_f32 v47, v47, v111
    v_mul_f32 v116, v44, v44
    v_mul_f32 v117, v45, v45
    v_mul_f32 v118, v46, v46
    v_mul_f32 v119, v47, v47
    v_fma_f32 v116, v116, s60, v9
    v_fma_f32 v117, v117, s60, v9
    v_fma_f32 v118, v118, s60, v9
    v_fma_f32 v119, v119, s60, v9
    v_mul_f32 v116, v116, v44
    v_mul_f32 v117, v117, v45
    v_mul_f32 v118, v118, v46
    v_mul_f32 v119, v119, v47
    v_exp_f32 v116, v116
    v_exp_f32 v117, v117
    v_exp_f32 v118, v118
    v_exp_f32 v119, v119
    v_add_f32 v116, 1.0, v116
    v_add_f32 v117, 1.0, v117
    v_add_f32 v118, 1.0, v118
    v_add_f32 v119, 1.0, v119
    v_rcp_f32 v116, v116
    v_rcp_f32 v117, v117
    v_rcp_f32 v118, v118
    v_rcp_f32 v119, v119
    v_mul_f32 v44, v44, v116
    v_mul_f32 v45, v45, v117
    v_mul_f32 v46, v46, v118
    v_mul_f32 v47, v47, v119
    v_cvt_pk_bf16_f32 v30, v44, v45
    v_cvt_pk_bf16_f32 v31, v46, v47
    s_nop 1
    v_mfma_f32_32x32x16_bf16 v[128:143], v[200:203], v[28:31], v[128:143]
    s_nop 11
    v_mov_b32 v129, s27
    buffer_store_dwordx2 v[128:129], v4, s[28:31], s61 offen sc0 sc1
    s_endpgm
L_xslow:
    s_sub_u32 s92, s92, 1
    s_cbranch_scc1 L_exit
    s_branch L_xchk
L_dslow:
    s_sub_u32 s92, s92, 1
    s_cbranch_scc1 L_exit
    global_load_dwordx2 v[2:3], v5, s[22:23] sc1
    s_waitcnt vmcnt(0)
    s_branch L_dtag
L_cwave:
    s_setprio 0
    s_load_dword s63, s[18:19], 0
    s_mov_b32 s36, s12
    s_mov_b32 s37, s13
    s_mov_b32 s38, 5537792
    s_mov_b32 s39, 0x20000
    s_and_b32 s61, s42, 7
    s_mul_i32 s61, s61, 12
    s_lshr_b32 s61, s61, 3
    s_lshr_b32 s46, s40, 1
    s_and_b32 s47, s40, 1
    v_and_b32 v14, 1, v12
    v_lshlrev_b32 v14, 2, v14
    v_xor_b32 v14, v11, v14
    v_lshlrev_b32 v14, 4, v14
    s_movk_i32 s58, 3328
    v_mad_u32_u24 v4, v10, s58, v14
    s_mul_i32 s44, s61, 212992
    s_mul_i32 s58, s47, 53248
    s_lshl_b32 s59, s41, 7
    s_add_u32 s58, s58, s59
    s_mul_i32 s59, s46, 2768896
    s_add_u32 s58, s58, s59
    v_add_u32 v4, s58, v4
    v_add_u32 v5, 25600, v4
    s_lshl_b32 s26, s40, 11
    s_add_u32 s26, s26, 131072
    v_lshrrev_b32 v11, 5, v1
    v_and_b32 v10, 31, v1
    s_lshl_b32 s61, s93, 2
    s_add_u32 s61, s61, s40
    s_mul_i32 s58, s40, 104
    s_add_u32 s58, s58, 160768
    v_subrev_u32 v13, 26, v1
    v_min_u32 v13, v13, v1
    v_lshl_add_u32 v13, v13, 2, s58
    s_lshl_b32 s58, s40, 8
    s_add_u32 s58, s58, 161792
    v_lshl_add_u32 v12, v11, 2, s58
    v_lshrrev_b32 v14, 2, v10
    v_lshlrev_b32 v14, 4, v14
    v_and_b32 v15, 3, v10
    v_lshl_add_u32 v14, v15, 2, v14
    v_lshl_add_u32 v15, v1, 2, s58
    s_and_b32 s96, s3, 31
    s_lshl_b32 s96, s96, 12
    s_mov_b32 m0, s96
    s_add_u32 s3, s3, 8
    buffer_load_dwordx4 v2, s[32:35], s96 offen offset:0  lds
    s_waitcnt vmcnt(9)
    s_barrier
    ds_read_b32 v62, v13
    s_waitcnt lgkmcnt(0)
    v_lshlrev_b32 v63, 3, v62
    v_and_b32 v63, 0x70, v63
    buffer_load_dwordx4 v3, s[32:35], s96 offen offset:1024  lds
    v_lshl_add_u32 v62, v62, 7, v63
    ds_write_b32 v15, v62
    ds_read_b32 v36, v12 offset:0
    ds_read_b32 v37, v12 offset:4
    buffer_load_dwordx4 v2, s[32:35], s96 offen offset:2048  lds
    ds_read_b32 v38, v12 offset:8
    ds_read_b32 v39, v12 offset:12
    ds_read_b32 v40, v12 offset:16
    ds_read_b32 v41, v12 offset:20
    buffer_load_dwordx4 v3, s[32:35], s96 offen offset:3072  lds
    ds_read_b32 v42, v12 offset:24
    ds_read_b32 v43, v12 offset:28
    ds_read_b32 v44, v12 offset:32
    ds_read_b32 v45, v12 offset:36
    s_and_b32 s96, s3, 31
    s_lshl_b32 s96, s96, 12
    s_mov_b32 m0, s96
    s_add_u32 s3, s3, 8
    buffer_load_dwordx4 v2, s[32:35], s96 offen offset:0  lds
    ds_read_b32 v46, v12 offset:40
    ds_read_b32 v47, v12 offset:44
    ds_read_b32 v48, v12 offset:48
    ds_read_b32 v49, v12 offset:52
    buffer_load_dwordx4 v3, s[32:35], s96 offen offset:1024  lds
    ds_read_b32 v50, v12 offset:56
    ds_read_b32 v51, v12 offset:60
    ds_read_b32 v52, v12 offset:64
    ds_read_b32 v53, v12 offset:68
    buffer_load_dwordx4 v2, s[32:35], s96 offen offset:2048  lds
    ds_read_b32 v54, v12 offset:72
    ds_read_b32 v55, v12 offset:76
    ds_read_b32 v56, v12 offset:80
    ds_read_b32 v57, v12 offset:84
    buffer_load_dwordx4 v3, s[32:35], s96 offen offset:3072  lds
    ds_read_b32 v58, v12 offset:88
    ds_read_b32 v59, v12 offset:92
    ds_read_b32 v60, v12 offset:96
    ds_read_b32 v61, v12 offset:100
    s_waitcnt lgkmcnt(15)
    v_xor_b32 v36, v14, v36
    v_xor_b32 v37, v14, v37
    v_xor_b32 v38, v14, v38
    v_xor_b32 v39, v14, v39
    v_xor_b32 v40, v14, v40
    v_xor_b32 v41, v14, v41
    v_xor_b32 v42, v14, v42
    v_xor_b32 v43, v14, v43
    v_xor_b32 v44, v14, v44
    v_xor_b32 v45, v14, v45
    v_xor_b32 v46, v14, v46
    s_waitcnt lgkmcnt(14)
    v_xor_b32 v47, v14, v47
    s_waitcnt lgkmcnt(13)
    v_xor_b32 v48, v14, v48
    s_waitcnt lgkmcnt(12)
    v_xor_b32 v49, v14, v49
    s_waitcnt lgkmcnt(11)
    v_xor_b32 v50, v14, v50
    s_waitcnt lgkmcnt(10)
    v_xor_b32 v51, v14, v51
    s_waitcnt lgkmcnt(9)
    v_xor_b32 v52, v14, v52
    s_waitcnt lgkmcnt(8)
    v_xor_b32 v53, v14, v53
    s_waitcnt lgkmcnt(7)
    v_xor_b32 v54, v14, v54
    s_waitcnt lgkmcnt(6)
    v_xor_b32 v55, v14, v55
    s_waitcnt lgkmcnt(5)
    v_xor_b32 v56, v14, v56
    s_waitcnt lgkmcnt(4)
    v_xor_b32 v57, v14, v57
    s_waitcnt lgkmcnt(3)
    v_xor_b32 v58, v14, v58
    s_waitcnt lgkmcnt(2)
    v_xor_b32 v59, v14, v59
    s_waitcnt lgkmcnt(1)
    v_xor_b32 v60, v14, v60
    s_waitcnt lgkmcnt(0)
    v_xor_b32 v61, v14, v61
    s_barrier
    s_add_u32 m0, s26, 0
    s_nop 0
    buffer_load_dwordx4 v4, s[36:39], s44 offen  lds
    buffer_load_dwordx4 v5, s[36:39], s44 offen offset:1024  lds
    s_add_u32 s44, s44, 106496
    s_add_u32 m0, s26, 8192
    s_nop 0
    buffer_load_dwordx4 v4, s[36:39], s44 offen  lds
    buffer_load_dwordx4 v5, s[36:39], s44 offen offset:1024  lds
    s_add_u32 s44, s44, 106496
    s_sub_u32 s45, s44, 2768896
    s_min_u32 s44, s44, s45
    s_add_u32 m0, s26, 16384
    s_nop 0
    buffer_load_dwordx4 v4, s[36:39], s44 offen  lds
    buffer_load_dwordx4 v5, s[36:39], s44 offen offset:1024  lds
    s_add_u32 s44, s44, 106496
    s_add_u32 m0, s26, 24576
    s_nop 0
    buffer_load_dwordx4 v4, s[36:39], s44 offen  lds
    buffer_load_dwordx4 v5, s[36:39], s44 offen offset:1024  lds
    s_add_u32 s44, s44, 106496
    s_sub_u32 s45, s44, 2768896
    s_min_u32 s44, s44, s45
    s_waitcnt vmcnt(6)
    s_barrier
    ds_read_b32 v36, v36
    ds_read_b32 v37, v37
    ds_read_b32 v38, v38
    ds_read_b32 v39, v39
    ds_read_b32 v40, v40
    ds_read_b32 v41, v41
    ds_read_b32 v42, v42
    ds_read_b32 v43, v43
    ds_read_b32 v44, v44
    ds_read_b32 v45, v45
    ds_read_b32 v46, v46
    ds_read_b32 v47, v47
    ds_read_b32 v48, v48
    ds_read_b32 v49, v49
    ds_read_b32 v50, v50
    ds_read_b32 v51, v51
    ds_read_b32 v52, v52
    ds_read_b32 v53, v53
    ds_read_b32 v54, v54
    ds_read_b32 v55, v55
    ds_read_b32 v56, v56
    ds_read_b32 v57, v57
    ds_read_b32 v58, v58
    ds_read_b32 v59, v59
    ds_read_b32 v60, v60
    ds_read_b32 v61, v61
    s_waitcnt vmcnt(4)
    s_barrier
    s_add_u32 m0, s26, 0
    s_nop 0
    buffer_load_dwordx4 v4, s[36:39], s44 offen  lds
    buffer_load_dwordx4 v5, s[36:39], s44 offen offset:1024  lds
    s_add_u32 s44, s44, 106496
    s_waitcnt lgkmcnt(15)
    v_lshlrev_b32 v10, 16, v36
    v_and_b32 v36, 0xffff0000, v36
    v_lshlrev_b32 v11, 16, v37
    v_and_b32 v37, 0xffff0000, v37
    v_lshlrev_b32 v12, 16, v38
    v_and_b32 v38, 0xffff0000, v38
    v_lshlrev_b32 v13, 16, v39
    v_and_b32 v39, 0xffff0000, v39
    v_lshlrev_b32 v14, 16, v40
    v_and_b32 v40, 0xffff0000, v40
    v_lshlrev_b32 v15, 16, v41
    v_and_b32 v41, 0xffff0000, v41
    v_lshlrev_b32 v16, 16, v42
    v_and_b32 v42, 0xffff0000, v42
    v_lshlrev_b32 v17, 16, v43
    v_and_b32 v43, 0xffff0000, v43
    v_lshlrev_b32 v18, 16, v44
    v_and_b32 v44, 0xffff0000, v44
    v_lshlrev_b32 v19, 16, v45
    v_and_b32 v45, 0xffff0000, v45
    v_lshlrev_b32 v20, 16, v46
    v_and_b32 v46, 0xffff0000, v46
    s_waitcnt lgkmcnt(14)
    v_lshlrev_b32 v21, 16, v47
    v_and_b32 v47, 0xffff0000, v47
    s_waitcnt lgkmcnt(13)
    v_lshlrev_b32 v22, 16, v48
    v_and_b32 v48, 0xffff0000, v48
    s_waitcnt lgkmcnt(12)
    v_lshlrev_b32 v23, 16, v49
    v_and_b32 v49, 0xffff0000, v49
    s_waitcnt lgkmcnt(11)
    v_lshlrev_b32 v24, 16, v50
    s_waitcnt vmcnt(4)
    s_barrier
    s_add_u32 m0, s26, 8192
    s_nop 0
    buffer_load_dwordx4 v4, s[36:39], s44 offen  lds
    buffer_load_dwordx4 v5, s[36:39], s44 offen offset:1024  lds
    s_add_u32 s44, s44, 106496
    s_sub_u32 s45, s44, 2768896
    s_min_u32 s44, s44, s45
    v_and_b32 v50, 0xffff0000, v50
    s_waitcnt lgkmcnt(10)
    v_lshlrev_b32 v25, 16, v51
    v_and_b32 v51, 0xffff0000, v51
    s_waitcnt lgkmcnt(9)
    v_lshlrev_b32 v26, 16, v52
    v_and_b32 v52, 0xffff0000, v52
    s_waitcnt lgkmcnt(8)
    v_lshlrev_b32 v27, 16, v53
    v_and_b32 v53, 0xffff0000, v53
    s_waitcnt lgkmcnt(7)
    v_lshlrev_b32 v28, 16, v54
    v_and_b32 v54, 0xffff0000, v54
    s_waitcnt lgkmcnt(6)
    v_lshlrev_b32 v29, 16, v55
    v_and_b32 v55, 0xffff0000, v55
    s_waitcnt lgkmcnt(5)
    v_lshlrev_b32 v30, 16, v56
    v_and_b32 v56, 0xffff0000, v56
    s_waitcnt lgkmcnt(4)
    v_lshlrev_b32 v31, 16, v57
    v_and_b32 v57, 0xffff0000, v57
    s_waitcnt lgkmcnt(3)
    v_lshlrev_b32 v32, 16, v58
    v_and_b32 v58, 0xffff0000, v58
    s_waitcnt lgkmcnt(2)
    v_lshlrev_b32 v33, 16, v59
    v_and_b32 v59, 0xffff0000, v59
    s_waitcnt lgkmcnt(1)
    v_lshlrev_b32 v34, 16, v60
    v_and_b32 v60, 0xffff0000, v60
    s_waitcnt lgkmcnt(0)
    v_lshlrev_b32 v35, 16, v61
    v_and_b32 v61, 0xffff0000, v61
    v_mul_f32 v62, v10, v10
    v_mul_f32 v63, v12, v12
    v_mul_f32 v64, v14, v14
    v_mul_f32 v65, v16, v16
    v_cvt_pk_bf16_f32 v128, v62, v63
    v_mul_f32 v66, v18, v18
    s_waitcnt vmcnt(4)
    s_barrier
    s_add_u32 m0, s26, 16384
    s_nop 0
    buffer_load_dwordx4 v4, s[36:39], s44 offen  lds
    buffer_load_dwordx4 v5, s[36:39], s44 offen offset:1024  lds
    s_add_u32 s44, s44, 106496
    v_mul_f32 v67, v20, v20
    v_cvt_pk_bf16_f32 v129, v64, v65
    v_mul_f32 v62, v22, v22
    v_mul_f32 v63, v24, v24
    v_cvt_pk_bf16_f32 v130, v66, v67
    v_mul_f32 v64, v26, v26
    v_mul_f32 v65, v28, v28
    v_cvt_pk_bf16_f32 v131, v62, v63
    v_mul_f32 v66, v30, v30
    v_mul_f32 v67, v32, v32
    v_cvt_pk_bf16_f32 v132, v64, v65
    v_mul_f32 v62, v34, v34
    v_mul_f32 v63, v10, v11
    v_cvt_pk_bf16_f32 v133, v66, v67
    v_mul_f32 v64, v12, v13
    v_mul_f32 v65, v14, v15
    v_cvt_pk_bf16_f32 v134, v62, v63
    v_mul_f32 v66, v16, v17
    v_mul_f32 v67, v18, v19
    v_cvt_pk_bf16_f32 v135, v64, v65
    v_mul_f32 v62, v20, v21
    v_mul_f32 v63, v22, v23
    v_cvt_pk_bf16_f32 v136, v66, v67
    v_mul_f32 v64, v24, v25
    v_mul_f32 v65, v26, v27
    v_cvt_pk_bf16_f32 v137, v62, v63
    v_mul_f32 v66, v28, v29
    v_mul_f32 v67, v30, v31
    v_cvt_pk_bf16_f32 v138, v64, v65
    s_waitcnt vmcnt(4)
    s_barrier
    s_add_u32 m0, s26, 24576
    s_nop 0
    buffer_load_dwordx4 v4, s[36:39], s44 offen  lds
    buffer_load_dwordx4 v5, s[36:39], s44 offen offset:1024  lds
    s_add_u32 s44, s44, 106496
    s_sub_u32 s45, s44, 2768896
    s_min_u32 s44, s44, s45
    v_mul_f32 v62, v32, v33
    v_mul_f32 v63, v34, v35
    v_cvt_pk_bf16_f32 v139, v66, v67
    v_mul_f32 v64, v10, v12
    v_mul_f32 v65, v12, v14
    v_cvt_pk_bf16_f32 v140, v62, v63
    v_mul_f32 v66, v14, v16
    v_mul_f32 v67, v16, v18
    v_cvt_pk_bf16_f32 v141, v64, v65
    v_mul_f32 v62, v18, v20
    v_mul_f32 v63, v20, v22
    v_cvt_pk_bf16_f32 v142, v66, v67
    v_mul_f32 v64, v22, v24
    v_mul_f32 v65, v24, v26
    v_cvt_pk_bf16_f32 v143, v62, v63
    v_mul_f32 v66, v26, v28
    v_mul_f32 v67, v28, v30
    v_cvt_pk_bf16_f32 v144, v64, v65
    v_mul_f32 v62, v30, v32
    v_mul_f32 v63, v32, v34
    v_cvt_pk_bf16_f32 v145, v66, v67
    v_mul_f32 v64, v34, v10
    v_mul_f32 v65, v10, v13
    v_cvt_pk_bf16_f32 v146, v62, v63
    v_mul_f32 v66, v12, v15
    v_mul_f32 v67, v14, v17
    v_cvt_pk_bf16_f32 v147, v64, v65
    v_mul_f32 v62, v16, v19
    v_mul_f32 v63, v18, v21
    s_waitcnt vmcnt(4)
    s_barrier
    s_add_u32 m0, s26, 0
    s_nop 0
    buffer_load_dwordx4 v4, s[36:39], s44 offen  lds
    buffer_load_dwordx4 v5, s[36:39], s44 offen offset:1024  lds
    s_add_u32 s44, s44, 106496
    v_cvt_pk_bf16_f32 v148, v66, v67
    v_mul_f32 v64, v20, v23
    v_mul_f32 v65, v22, v25
    v_cvt_pk_bf16_f32 v149, v62, v63
    v_mul_f32 v66, v24, v27
    v_mul_f32 v67, v26, v29
    v_cvt_pk_bf16_f32 v150, v64, v65
    v_mul_f32 v62, v28, v31
    v_mul_f32 v63, v30, v33
    v_cvt_pk_bf16_f32 v151, v66, v67
    v_mul_f32 v64, v32, v35
    v_mul_f32 v65, v34, v11
    v_cvt_pk_bf16_f32 v152, v62, v63
    v_mul_f32 v66, v10, v14
    v_mul_f32 v67, v12, v16
    v_cvt_pk_bf16_f32 v153, v64, v65
    v_mul_f32 v62, v14, v18
    v_mul_f32 v63, v16, v20
    v_cvt_pk_bf16_f32 v154, v66, v67
    v_mul_f32 v64, v18, v22
    v_mul_f32 v65, v20, v24
    v_cvt_pk_bf16_f32 v155, v62, v63
    v_mul_f32 v66, v22, v26
    v_mul_f32 v67, v24, v28
    v_cvt_pk_bf16_f32 v156, v64, v65
    v_mul_f32 v62, v26, v30
    v_mul_f32 v63, v28, v32
    v_cvt_pk_bf16_f32 v157, v66, v67
    v_mul_f32 v64, v30, v34
    s_waitcnt vmcnt(4)
    s_barrier
    s_add_u32 m0, s26, 8192
    s_nop 0
    buffer_load_dwordx4 v4, s[36:39], s44 offen  lds
    buffer_load_dwordx4 v5, s[36:39], s44 offen offset:1024  lds
    s_add_u32 s44, s44, 106496
    s_sub_u32 s45, s44, 2768896
    s_min_u32 s44, s44, s45
    v_mul_f32 v65, v32, v10
    v_cvt_pk_bf16_f32 v158, v62, v63
    v_mul_f32 v66, v34, v12
    v_mul_f32 v67, v10, v15
    v_cvt_pk_bf16_f32 v159, v64, v65
    v_mul_f32 v62, v12, v17
    v_mul_f32 v63, v14, v19
    v_cvt_pk_bf16_f32 v160, v66, v67
    v_mul_f32 v64, v16, v21
    v_mul_f32 v65, v18, v23
    v_cvt_pk_bf16_f32 v161, v62, v63
    v_mul_f32 v66, v20, v25
    v_mul_f32 v67, v22, v27
    v_cvt_pk_bf16_f32 v162, v64, v65
    v_mul_f32 v62, v24, v29
    v_mul_f32 v63, v26, v31
    v_cvt_pk_bf16_f32 v163, v66, v67
    v_mul_f32 v64, v28, v33
    v_mul_f32 v65, v30, v35
    v_cvt_pk_bf16_f32 v164, v62, v63
    v_mul_f32 v66, v32, v11
    v_mul_f32 v67, v34, v13
    v_cvt_pk_bf16_f32 v165, v64, v65
    v_mul_f32 v62, v10, v16
    v_mul_f32 v63, v12, v18
    v_cvt_pk_bf16_f32 v166, v66, v67
    v_mul_f32 v64, v14, v20
    v_mul_f32 v65, v16, v22
    v_cvt_pk_bf16_f32 v167, v62, v63
    s_waitcnt vmcnt(4)
    s_barrier
    s_add_u32 m0, s26, 16384
    s_nop 0
    buffer_load_dwordx4 v4, s[36:39], s44 offen  lds
    buffer_load_dwordx4 v5, s[36:39], s44 offen offset:1024  lds
    s_add_u32 s44, s44, 106496
    v_mul_f32 v66, v18, v24
    v_mul_f32 v67, v20, v26
    v_cvt_pk_bf16_f32 v168, v64, v65
    v_mul_f32 v62, v22, v28
    v_mul_f32 v63, v24, v30
    v_cvt_pk_bf16_f32 v169, v66, v67
    v_mul_f32 v64, v26, v32
    v_mul_f32 v65, v28, v34
    v_cvt_pk_bf16_f32 v170, v62, v63
    v_mul_f32 v66, v30, v10
    v_mul_f32 v67, v32, v12
    v_cvt_pk_bf16_f32 v171, v64, v65
    v_mul_f32 v62, v34, v14
    v_mul_f32 v63, v10, v17
    v_cvt_pk_bf16_f32 v172, v66, v67
    v_mul_f32 v64, v12, v19
    v_mul_f32 v65, v14, v21
    v_cvt_pk_bf16_f32 v173, v62, v63
    v_mul_f32 v66, v16, v23
    v_mul_f32 v67, v18, v25
    v_cvt_pk_bf16_f32 v174, v64, v65
    v_mul_f32 v62, v20, v27
    v_mul_f32 v63, v22, v29
    v_cvt_pk_bf16_f32 v175, v66, v67
    v_mul_f32 v64, v24, v31
    v_mul_f32 v65, v26, v33
    v_cvt_pk_bf16_f32 v176, v62, v63
    v_mul_f32 v66, v28, v35
    v_mul_f32 v67, v30, v11
    s_waitcnt vmcnt(4)
    s_barrier
    s_add_u32 m0, s26, 24576
    s_nop 0
    buffer_load_dwordx4 v4, s[36:39], s44 offen  lds
    buffer_load_dwordx4 v5, s[36:39], s44 offen offset:1024  lds
    s_add_u32 s44, s44, 106496
    s_sub_u32 s45, s44, 2768896
    s_min_u32 s44, s44, s45
    v_cvt_pk_bf16_f32 v177, v64, v65
    v_mul_f32 v62, v32, v13
    v_mul_f32 v63, v34, v15
    v_cvt_pk_bf16_f32 v178, v66, v67
    v_mul_f32 v64, v10, v18
    v_mul_f32 v65, v12, v20
    v_cvt_pk_bf16_f32 v179, v62, v63
    v_mul_f32 v66, v14, v22
    v_mul_f32 v67, v16, v24
    v_cvt_pk_bf16_f32 v180, v64, v65
    v_mul_f32 v62, v18, v26
    v_mul_f32 v63, v20, v28
    v_cvt_pk_bf16_f32 v181, v66, v67
    v_mul_f32 v64, v22, v30
    v_mul_f32 v65, v24, v32
    v_cvt_pk_bf16_f32 v182, v62, v63
    v_mul_f32 v66, v26, v34
    v_mul_f32 v67, v28, v10
    v_cvt_pk_bf16_f32 v183, v64, v65
    v_mul_f32 v62, v30, v12
    v_mul_f32 v63, v32, v14
    v_cvt_pk_bf16_f32 v184, v66, v67
    v_mul_f32 v64, v34, v16
    v_mul_f32 v65, v10, v19
    v_cvt_pk_bf16_f32 v185, v62, v63
    v_mul_f32 v66, v12, v21
    v_mul_f32 v67, v14, v23
    v_cvt_pk_bf16_f32 v186, v64, v65
    v_mul_f32 v62, v16, v25
    s_waitcnt vmcnt(4)
    s_barrier
    s_add_u32 m0, s26, 0
    s_nop 0
    buffer_load_dwordx4 v4, s[36:39], s44 offen  lds
    buffer_load_dwordx4 v5, s[36:39], s44 offen offset:1024  lds
    s_add_u32 s44, s44, 106496
    v_mul_f32 v63, v18, v27
    v_cvt_pk_bf16_f32 v187, v66, v67
    v_mul_f32 v64, v20, v29
    v_mul_f32 v65, v22, v31
    v_cvt_pk_bf16_f32 v188, v62, v63
    v_mul_f32 v66, v24, v33
    v_mul_f32 v67, v26, v35
    v_cvt_pk_bf16_f32 v189, v64, v65
    v_mul_f32 v62, v28, v11
    v_mul_f32 v63, v30, v13
    v_cvt_pk_bf16_f32 v190, v66, v67
    v_mul_f32 v64, v32, v15
    v_mul_f32 v65, v34, v17
    v_cvt_pk_bf16_f32 v191, v62, v63
    v_mul_f32 v66, v10, v20
    v_mul_f32 v67, v12, v22
    v_cvt_pk_bf16_f32 v192, v64, v65
    v_mul_f32 v62, v14, v24
    v_mul_f32 v63, v16, v26
    v_cvt_pk_bf16_f32 v193, v66, v67
    v_mul_f32 v64, v18, v28
    v_mul_f32 v65, v20, v30
    v_cvt_pk_bf16_f32 v194, v62, v63
    v_mul_f32 v66, v22, v32
    v_mul_f32 v67, v24, v34
    v_cvt_pk_bf16_f32 v195, v64, v65
    v_mul_f32 v62, v26, v10
    v_mul_f32 v63, v28, v12
    v_cvt_pk_bf16_f32 v196, v66, v67
    s_waitcnt vmcnt(4)
    s_barrier
    s_add_u32 m0, s26, 8192
    s_nop 0
    buffer_load_dwordx4 v4, s[36:39], s44 offen  lds
    buffer_load_dwordx4 v5, s[36:39], s44 offen offset:1024  lds
    s_add_u32 s44, s44, 106496
    s_sub_u32 s45, s44, 2768896
    s_min_u32 s44, s44, s45
    v_mul_f32 v64, v30, v14
    v_mul_f32 v65, v32, v16
    v_cvt_pk_bf16_f32 v197, v62, v63
    v_mul_f32 v66, v34, v18
    v_mul_f32 v67, v10, v21
    v_cvt_pk_bf16_f32 v198, v64, v65
    v_mul_f32 v62, v12, v23
    v_mul_f32 v63, v14, v25
    v_cvt_pk_bf16_f32 v199, v66, v67
    v_mul_f32 v64, v16, v27
    v_mul_f32 v65, v18, v29
    v_cvt_pk_bf16_f32 v200, v62, v63
    v_mul_f32 v66, v20, v31
    v_mul_f32 v67, v22, v33
    v_cvt_pk_bf16_f32 v201, v64, v65
    v_mul_f32 v62, v24, v35
    v_mul_f32 v63, v26, v11
    v_cvt_pk_bf16_f32 v202, v66, v67
    v_mul_f32 v64, v28, v13
    v_mul_f32 v65, v30, v15
    v_cvt_pk_bf16_f32 v203, v62, v63
    v_mul_f32 v66, v32, v17
    v_mul_f32 v67, v34, v19
    v_cvt_pk_bf16_f32 v204, v64, v65
    v_mul_f32 v62, v10, v22
    v_mul_f32 v63, v12, v24
    v_cvt_pk_bf16_f32 v205, v66, v67
    v_mul_f32 v64, v14, v26
    v_mul_f32 v65, v16, v28
    s_waitcnt vmcnt(4)
    s_barrier
    s_add_u32 m0, s26, 16384
    s_nop 0
    buffer_load_dwordx4 v4, s[36:39], s44 offen  lds
    buffer_load_dwordx4 v5, s[36:39], s44 offen offset:1024  lds
    s_add_u32 s44, s44, 106496
    v_cvt_pk_bf16_f32 v206, v62, v63
    v_mul_f32 v66, v18, v30
    v_mul_f32 v67, v20, v32
    v_cvt_pk_bf16_f32 v207, v64, v65
    v_mul_f32 v62, v22, v34
    v_mul_f32 v63, v24, v10
    v_cvt_pk_bf16_f32 v208, v66, v67
    v_mul_f32 v64, v26, v12
    v_mul_f32 v65, v28, v14
    v_cvt_pk_bf16_f32 v209, v62, v63
    v_mul_f32 v66, v30, v16
    v_mul_f32 v67, v32, v18
    v_cvt_pk_bf16_f32 v210, v64, v65
    v_mul_f32 v62, v34, v20
    v_mul_f32 v63, v10, v23
    v_cvt_pk_bf16_f32 v211, v66, v67
    v_mul_f32 v64, v12, v25
    v_mul_f32 v65, v14, v27
    v_cvt_pk_bf16_f32 v212, v62, v63
    v_mul_f32 v66, v16, v29
    v_mul_f32 v67, v18, v31
    v_cvt_pk_bf16_f32 v213, v64, v65
    v_mul_f32 v62, v20, v33
    v_mul_f32 v63, v22, v35
    v_cvt_pk_bf16_f32 v214, v66, v67
    v_cvt_pk_bf16_f32 v215, v62, v63
    v_cvt_pk_bf16_f32 v216, v10, v12
    v_cvt_pk_bf16_f32 v217, v14, v16
    v_cvt_pk_bf16_f32 v218, v18, v20
    s_waitcnt vmcnt(4)
    s_barrier
    s_add_u32 m0, s26, 24576
    s_nop 0
    buffer_load_dwordx4 v4, s[36:39], s44 offen  lds
    buffer_load_dwordx4 v5, s[36:39], s44 offen offset:1024  lds
    s_add_u32 s44, s44, 106496
    s_sub_u32 s45, s44, 2768896
    s_min_u32 s44, s44, s45
    v_cvt_pk_bf16_f32 v219, v22, v24
    v_cvt_pk_bf16_f32 v220, v26, v28
    v_cvt_pk_bf16_f32 v221, v30, v32
    v_cvt_pk_bf16_f32 v222, v34, 1.0
    v_mul_f32 v64, v36, v36
    v_mul_f32 v65, v38, v38
    v_cvt_pk_bf16_f32 v223, 0, 0
    v_mul_f32 v66, v40, v40
    v_mul_f32 v67, v42, v42
    v_cvt_pk_bf16_f32 v224, v64, v65
    v_mul_f32 v62, v44, v44
    v_mul_f32 v63, v46, v46
    v_cvt_pk_bf16_f32 v225, v66, v67
    v_mul_f32 v64, v48, v48
    v_mul_f32 v65, v50, v50
    v_cvt_pk_bf16_f32 v226, v62, v63
    v_mul_f32 v66, v52, v52
    v_mul_f32 v67, v54, v54
    v_cvt_pk_bf16_f32 v227, v64, v65
    v_mul_f32 v62, v56, v56
    v_mul_f32 v63, v58, v58
    v_cvt_pk_bf16_f32 v228, v66, v67
    v_mul_f32 v64, v60, v60
    v_mul_f32 v65, v36, v37
    v_cvt_pk_bf16_f32 v229, v62, v63
    v_mul_f32 v66, v38, v39
    v_mul_f32 v67, v40, v41
    v_cvt_pk_bf16_f32 v230, v64, v65
    v_mul_f32 v62, v42, v43
    s_waitcnt vmcnt(4)
    s_barrier
    s_add_u32 m0, s26, 0
    s_nop 0
    buffer_load_dwordx4 v4, s[36:39], s44 offen  lds
    buffer_load_dwordx4 v5, s[36:39], s44 offen offset:1024  lds
    s_add_u32 s44, s44, 106496
    v_mul_f32 v63, v44, v45
    v_cvt_pk_bf16_f32 v231, v66, v67
    v_mul_f32 v64, v46, v47
    v_mul_f32 v65, v48, v49
    v_cvt_pk_bf16_f32 v232, v62, v63
    v_mul_f32 v66, v50, v51
    v_mul_f32 v67, v52, v53
    v_cvt_pk_bf16_f32 v233, v64, v65
    v_mul_f32 v62, v54, v55
    v_mul_f32 v63, v56, v57
    v_cvt_pk_bf16_f32 v234, v66, v67
    v_mul_f32 v64, v58, v59
    v_mul_f32 v65, v60, v61
    v_cvt_pk_bf16_f32 v235, v62, v63
    v_mul_f32 v66, v36, v38
    v_mul_f32 v67, v38, v40
    v_cvt_pk_bf16_f32 v236, v64, v65
    v_mul_f32 v62, v40, v42
    v_mul_f32 v63, v42, v44
    v_cvt_pk_bf16_f32 v237, v66, v67
    v_mul_f32 v64, v44, v46
    v_mul_f32 v65, v46, v48
    v_cvt_pk_bf16_f32 v238, v62, v63
    v_mul_f32 v66, v48, v50
    v_mul_f32 v67, v50, v52
    v_cvt_pk_bf16_f32 v239, v64, v65
    v_mul_f32 v62, v52, v54
    v_mul_f32 v63, v54, v56
    v_cvt_pk_bf16_f32 v240, v66, v67
    s_waitcnt vmcnt(4)
    s_barrier
    s_add_u32 m0, s26, 8192
    s_nop 0
    buffer_load_dwordx4 v4, s[36:39], s44 offen  lds
    buffer_load_dwordx4 v5, s[36:39], s44 offen offset:1024  lds
    s_add_u32 s44, s44, 106496
    s_sub_u32 s45, s44, 2768896
    s_min_u32 s44, s44, s45
    v_mul_f32 v64, v56, v58
    v_mul_f32 v65, v58, v60
    v_cvt_pk_bf16_f32 v241, v62, v63
    v_mul_f32 v66, v60, v36
    v_mul_f32 v67, v36, v39
    v_cvt_pk_bf16_f32 v242, v64, v65
    v_mul_f32 v62, v38, v41
    v_mul_f32 v63, v40, v43
    v_cvt_pk_bf16_f32 v243, v66, v67
    v_mul_f32 v64, v42, v45
    v_mul_f32 v65, v44, v47
    v_cvt_pk_bf16_f32 v244, v62, v63
    v_mul_f32 v66, v46, v49
    v_mul_f32 v67, v48, v51
    v_cvt_pk_bf16_f32 v245, v64, v65
    v_mul_f32 v62, v50, v53
    v_mul_f32 v63, v52, v55
    v_cvt_pk_bf16_f32 v246, v66, v67
    v_mul_f32 v64, v54, v57
    v_mul_f32 v65, v56, v59
    v_cvt_pk_bf16_f32 v247, v62, v63
    v_mul_f32 v66, v58, v61
    v_mul_f32 v67, v60, v37
    v_cvt_pk_bf16_f32 v248, v64, v65
    v_mul_f32 v62, v36, v40
    v_mul_f32 v63, v38, v42
    v_cvt_pk_bf16_f32 v249, v66, v67
    v_mul_f32 v64, v40, v44
    v_mul_f32 v65, v42, v46
    s_waitcnt vmcnt(4)
    s_barrier
    s_add_u32 m0, s26, 16384
    s_nop 0
    buffer_load_dwordx4 v4, s[36:39], s44 offen  lds
    buffer_load_dwordx4 v5, s[36:39], s44 offen offset:1024  lds
    s_add_u32 s44, s44, 106496
    v_cvt_pk_bf16_f32 v250, v62, v63
    v_mul_f32 v66, v44, v48
    v_mul_f32 v67, v46, v50
    v_cvt_pk_bf16_f32 v251, v64, v65
    v_mul_f32 v62, v48, v52
    v_mul_f32 v63, v50, v54
    v_cvt_pk_bf16_f32 v252, v66, v67
    v_mul_f32 v64, v52, v56
    v_mul_f32 v65, v54, v58
    v_cvt_pk_bf16_f32 v253, v62, v63
    v_mul_f32 v66, v56, v60
    v_mul_f32 v67, v58, v36
    v_cvt_pk_bf16_f32 v254, v64, v65
    v_mul_f32 v62, v60, v38
    v_mul_f32 v63, v36, v41
    v_cvt_pk_bf16_f32 v255, v66, v67
    v_mul_f32 v64, v38, v43
    v_mul_f32 v65, v40, v45
    v_cvt_pk_bf16_f32 v72, v62, v63
    v_mul_f32 v66, v42, v47
    v_mul_f32 v67, v44, v49
    v_cvt_pk_bf16_f32 v73, v64, v65
    v_mul_f32 v62, v46, v51
    v_mul_f32 v63, v48, v53
    v_cvt_pk_bf16_f32 v74, v66, v67
    v_mul_f32 v64, v50, v55
    v_mul_f32 v65, v52, v57
    v_cvt_pk_bf16_f32 v75, v62, v63
    v_mul_f32 v66, v54, v59
    s_waitcnt vmcnt(4)
    s_barrier
    s_add_u32 m0, s26, 24576
    s_nop 0
    buffer_load_dwordx4 v4, s[36:39], s44 offen  lds
    buffer_load_dwordx4 v5, s[36:39], s44 offen offset:1024  lds
    s_add_u32 s44, s44, 106496
    s_sub_u32 s45, s44, 2768896
    s_min_u32 s44, s44, s45
    v_mul_f32 v67, v56, v61
    v_cvt_pk_bf16_f32 v76, v64, v65
    v_mul_f32 v62, v58, v37
    v_mul_f32 v63, v60, v39
    v_cvt_pk_bf16_f32 v77, v66, v67
    v_mul_f32 v64, v36, v42
    v_mul_f32 v65, v38, v44
    v_cvt_pk_bf16_f32 v78, v62, v63
    v_mul_f32 v66, v40, v46
    v_mul_f32 v67, v42, v48
    v_cvt_pk_bf16_f32 v79, v64, v65
    v_mul_f32 v62, v44, v50
    v_mul_f32 v63, v46, v52
    v_cvt_pk_bf16_f32 v80, v66, v67
    v_mul_f32 v64, v48, v54
    v_mul_f32 v65, v50, v56
    v_cvt_pk_bf16_f32 v81, v62, v63
    v_mul_f32 v66, v52, v58
    v_mul_f32 v67, v54, v60
    v_cvt_pk_bf16_f32 v82, v64, v65
    v_mul_f32 v62, v56, v36
    v_mul_f32 v63, v58, v38
    v_cvt_pk_bf16_f32 v83, v66, v67
    v_mul_f32 v64, v60, v40
    v_mul_f32 v65, v36, v43
    v_cvt_pk_bf16_f32 v84, v62, v63
    v_mul_f32 v66, v38, v45
    v_mul_f32 v67, v40, v47
    v_cvt_pk_bf16_f32 v85, v64, v65
    s_waitcnt vmcnt(4)
    s_barrier
    s_add_u32 m0, s26, 0
    s_nop 0
    buffer_load_dwordx4 v4, s[36:39], s44 offen  lds
    buffer_load_dwordx4 v5, s[36:39], s44 offen offset:1024  lds
    s_add_u32 s44, s44, 106496
    v_mul_f32 v62, v42, v49
    v_mul_f32 v63, v44, v51
    v_cvt_pk_bf16_f32 v86, v66, v67
    v_mul_f32 v64, v46, v53
    v_mul_f32 v65, v48, v55
    v_cvt_pk_bf16_f32 v87, v62, v63
    v_mul_f32 v66, v50, v57
    v_mul_f32 v67, v52, v59
    v_cvt_pk_bf16_f32 v88, v64, v65
    v_mul_f32 v62, v54, v61
    v_mul_f32 v63, v56, v37
    v_cvt_pk_bf16_f32 v89, v66, v67
    v_mul_f32 v64, v58, v39
    v_mul_f32 v65, v60, v41
    v_cvt_pk_bf16_f32 v90, v62, v63
    v_mul_f32 v66, v36, v44
    v_mul_f32 v67, v38, v46
    v_cvt_pk_bf16_f32 v91, v64, v65
    v_mul_f32 v62, v40, v48
    v_mul_f32 v63, v42, v50
    v_cvt_pk_bf16_f32 v92, v66, v67
    v_mul_f32 v64, v44, v52
    v_mul_f32 v65, v46, v54
    v_cvt_pk_bf16_f32 v93, v62, v63
    v_mul_f32 v66, v48, v56
    v_mul_f32 v67, v50, v58
    v_cvt_pk_bf16_f32 v94, v64, v65
    v_mul_f32 v62, v52, v60
    v_mul_f32 v63, v54, v36
    s_waitcnt vmcnt(4)
    s_barrier
    s_add_u32 m0, s26, 8192
    s_nop 0
    buffer_load_dwordx4 v4, s[36:39], s44 offen  lds
    buffer_load_dwordx4 v5, s[36:39], s44 offen offset:1024  lds
    s_add_u32 s44, s44, 106496
    s_sub_u32 s45, s44, 2768896
    s_min_u32 s44, s44, s45
    v_cvt_pk_bf16_f32 v95, v66, v67
    v_mul_f32 v64, v56, v38
    v_mul_f32 v65, v58, v40
    v_cvt_pk_bf16_f32 v96, v62, v63
    v_mul_f32 v66, v60, v42
    v_mul_f32 v67, v36, v45
    v_cvt_pk_bf16_f32 v97, v64, v65
    v_mul_f32 v62, v38, v47
    v_mul_f32 v63, v40, v49
    v_cvt_pk_bf16_f32 v98, v66, v67
    v_mul_f32 v64, v42, v51
    v_mul_f32 v65, v44, v53
    v_cvt_pk_bf16_f32 v99, v62, v63
    v_mul_f32 v66, v46, v55
    v_mul_f32 v67, v48, v57
    v_cvt_pk_bf16_f32 v100, v64, v65
    v_mul_f32 v62, v50, v59
    v_mul_f32 v63, v52, v61
    v_cvt_pk_bf16_f32 v101, v66, v67
    v_mul_f32 v64, v54, v37
    v_mul_f32 v65, v56, v39
    v_cvt_pk_bf16_f32 v102, v62, v63
    v_mul_f32 v66, v58, v41
    v_mul_f32 v67, v60, v43
    v_cvt_pk_bf16_f32 v103, v64, v65
    v_mul_f32 v62, v36, v46
    v_mul_f32 v63, v38, v48
    v_cvt_pk_bf16_f32 v104, v66, v67
    v_mul_f32 v64, v40, v50
    s_waitcnt vmcnt(4)
    s_barrier
    s_add_u32 m0, s26, 16384
    s_nop 0
    buffer_load_dwordx4 v4, s[36:39], s44 offen  lds
    buffer_load_dwordx4 v5, s[36:39], s44 offen offset:1024  lds
    s_add_u32 s44, s44, 106496
    v_mul_f32 v65, v42, v52
    v_cvt_pk_bf16_f32 v105, v62, v63
    v_mul_f32 v66, v44, v54
    v_mul_f32 v67, v46, v56
    v_cvt_pk_bf16_f32 v106, v64, v65
    v_mul_f32 v62, v48, v58
    v_mul_f32 v63, v50, v60
    v_cvt_pk_bf16_f32 v107, v66, v67
    v_mul_f32 v64, v52, v36
    v_mul_f32 v65, v54, v38
    v_cvt_pk_bf16_f32 v108, v62, v63
    v_mul_f32 v66, v56, v40
    v_mul_f32 v67, v58, v42
    v_cvt_pk_bf16_f32 v109, v64, v65
    v_mul_f32 v62, v60, v44
    v_mul_f32 v63, v36, v47
    v_cvt_pk_bf16_f32 v110, v66, v67
    v_mul_f32 v64, v38, v49
    v_mul_f32 v65, v40, v51
    v_cvt_pk_bf16_f32 v111, v62, v63
    v_mul_f32 v66, v42, v53
    v_mul_f32 v67, v44, v55
    v_cvt_pk_bf16_f32 v112, v64, v65
    v_mul_f32 v62, v46, v57
    v_mul_f32 v63, v48, v59
    v_cvt_pk_bf16_f32 v113, v66, v67
    v_mul_f32 v64, v50, v61
    v_mul_f32 v65, v52, v37
    v_cvt_pk_bf16_f32 v114, v62, v63
    s_waitcnt vmcnt(4)
    s_barrier
    s_add_u32 m0, s26, 24576
    s_nop 0
    buffer_load_dwordx4 v4, s[36:39], s44 offen  lds
    buffer_load_dwordx4 v5, s[36:39], s44 offen offset:1024  lds
    s_add_u32 s44, s44, 106496
    s_sub_u32 s45, s44, 2768896
    s_min_u32 s44, s44, s45
    v_mul_f32 v66, v54, v39
    v_mul_f32 v67, v56, v41
    v_cvt_pk_bf16_f32 v115, v64, v65
    v_mul_f32 v62, v58, v43
    v_mul_f32 v63, v60, v45
    v_cvt_pk_bf16_f32 v116, v66, v67
    v_mul_f32 v64, v36, v48
    v_mul_f32 v65, v38, v50
    v_cvt_pk_bf16_f32 v117, v62, v63
    v_mul_f32 v66, v40, v52
    v_mul_f32 v67, v42, v54
    v_cvt_pk_bf16_f32 v118, v64, v65
    v_mul_f32 v62, v44, v56
    v_mul_f32 v63, v46, v58
    v_cvt_pk_bf16_f32 v119, v66, v67
    v_mul_f32 v64, v48, v60
    v_mul_f32 v65, v50, v36
    v_cvt_pk_bf16_f32 v120, v62, v63
    v_mul_f32 v66, v52, v38
    v_mul_f32 v67, v54, v40
    v_cvt_pk_bf16_f32 v121, v64, v65
    v_mul_f32 v62, v56, v42
    v_mul_f32 v63, v58, v44
    v_cvt_pk_bf16_f32 v122, v66, v67
    v_mul_f32 v64, v60, v46
    v_mul_f32 v65, v36, v49
    v_cvt_pk_bf16_f32 v123, v62, v63
    v_mul_f32 v66, v38, v51
    v_mul_f32 v67, v40, v53
    v_min_u32 v8, 12, v1
    v_lshlrev_b32 v8, 7, v8
    v_add_u32 v8, 49152, v8
    v_mov_b32 v7, 0
    global_load_dwordx2 v[2:3], v7, s[22:23]
    global_load_dword v6, v8, s[24:25]
    s_waitcnt vmcnt(6)
    s_barrier
    s_add_u32 m0, s26, 0
    s_nop 0
    buffer_load_dwordx4 v4, s[36:39], s44 offen  lds
    buffer_load_dwordx4 v5, s[36:39], s44 offen offset:1024  lds
    s_add_u32 s44, s44, 106496
    v_cvt_pk_bf16_f32 v124, v64, v65
    v_mul_f32 v62, v42, v55
    v_mul_f32 v63, v44, v57
    v_cvt_pk_bf16_f32 v125, v66, v67
    v_mul_f32 v64, v46, v59
    v_mul_f32 v65, v48, v61
    v_cvt_pk_bf16_f32 v126, v62, v63
    v_cvt_pk_bf16_f32 v127, v64, v65
    v_cvt_pk_bf16_f32 v10, v36, v38
    v_cvt_pk_bf16_f32 v11, v40, v42
    v_cvt_pk_bf16_f32 v12, v44, v46
    v_cvt_pk_bf16_f32 v13, v48, v50
    v_cvt_pk_bf16_f32 v14, v52, v54
    v_cvt_pk_bf16_f32 v15, v56, v58
    v_cvt_pk_bf16_f32 v16, v60, 1.0
    v_cvt_pk_bf16_f32 v17, 0, 0
    s_waitcnt vmcnt(6)
    s_barrier
    s_add_u32 m0, s26, 8192
    s_nop 0
    buffer_load_dwordx4 v4, s[36:39], s44 offen  lds
    buffer_load_dwordx4 v5, s[36:39], s44 offen offset:1024  lds
    s_add_u32 s44, s44, 106496
    s_sub_u32 s45, s44, 2768896
    s_min_u32 s44, s44, s45
    s_mov_b32 s32, s24
    s_mov_b32 s33, s25
    s_mov_b32 s34, 47104
    s_mov_b32 s35, 0x20000
L_cwchk:
    s_waitcnt vmcnt(4)
    v_cmp_ne_u32 vcc, v3, v6
    v_cmp_eq_u32 s[58:59], 0, v2
    v_readfirstlane_b32 s27, v3
    s_or_b64 vcc, vcc, s[58:59]
    s_cbranch_scc1 L_cwslow
    s_barrier
    s_add_u32 m0, s26, 16384
    s_lshl_b32 s58, s40, 11
    buffer_load_dwordx4 v9, s[32:35], s58 offen offset:0 sc1 lds
    buffer_load_dwordx4 v9, s[32:35], s58 offen offset:1024 sc1 lds
    s_waitcnt vmcnt(4)
    s_barrier
    s_add_u32 m0, s26, 24576
    s_lshl_b32 s58, s40, 11
    s_add_u32 s58, s58, 8192
    buffer_load_dwordx4 v9, s[32:35], s58 offen offset:0 sc1 lds
    buffer_load_dwordx4 v9, s[32:35], s58 offen offset:1024 sc1 lds
    s_add_u32 s28, s24, 65536
    s_addc_u32 s29, s25, 0
    s_mov_b32 s30, 212992
    s_mov_b32 s31, 0x20000
    v_add_u32 v6, 131072, v9
    v_add_u32 v7, 65536, v9
    s_lshl_b32 s62, s61, 3
    v_lshlrev_b32 v4, 13, v1
    v_mov_b32 v5, 2147483647
    v_cmp_gt_u32 vcc, 26, v1
    s_nop 1
    v_cndmask_b32 v4, v5, v4, vcc
    s_mov_b32 s88, s20
    s_mov_b32 s89, s21
    s_mov_b32 s90, 2048
    s_mov_b32 s91, 0x20000
    s_lshl_b32 s63, s63, 16
    s_lshl_b32 s61, s61, 1
    s_lshl_b32 s59, s40, 8
    s_add_u32 s59, s59, 129024
    v_lshl_add_u32 v50, v1, 2, s59
    v_and_b32 v51, 3, v1
    v_lshlrev_b32 v51, 8, v51
    v_add_u32 v51, 129028, v51
    s_waitcnt vmcnt(4)
    s_barrier
    s_waitcnt vmcnt(2)
    s_barrier
    ds_read_b128 v[52:55], v6 offset:16384
    ds_read_b128 v[56:59], v6 offset:17408
    ds_read_b128 v[60:63], v6 offset:18432
    ds_read_b128 v[64:67], v6 offset:19456
    ds_read_b128 v[68:71], v6 offset:20480
    s_waitcnt lgkmcnt(4)
    v_mfma_f32_32x32x16_bf16 v[18:33], v[52:55], v[224:227], 0
    ds_read_b128 v[52:55], v6 offset:21504
    s_waitcnt lgkmcnt(4)
    v_mfma_f32_32x32x16_bf16 v[34:49], v[56:59], v[224:227], 0
    ds_read_b128 v[56:59], v6 offset:22528
    ds_read_b128 v[224:227], v6 offset:23552
    s_waitcnt lgkmcnt(5)
    v_mfma_f32_32x32x16_bf16 v[18:33], v[60:63], v[228:231], v[18:33]
    s_waitcnt vmcnt(0)
    s_barrier
    ds_read_b128 v[60:63], v6 offset:24576
    s_waitcnt lgkmcnt(5)
    v_mfma_f32_32x32x16_bf16 v[34:49], v[64:67], v[228:231], v[34:49]
    ds_read_b128 v[64:67], v6 offset:25600
    ds_read_b128 v[228:231], v6 offset:26624
    s_lshl_b32 s58, s40, 13
    s_add_u32 m0, s58, 65536
    s_add_u32 s58, s58, 16384
    buffer_load_dwordx4 v9, s[32:35], s58 offen offset:0 sc1 lds
    s_waitcnt lgkmcnt(6)
    v_mfma_f32_32x32x16_bf16 v[18:33], v[68:71], v[232:235], v[18:33]
    ds_read_b128 v[68:71], v6 offset:27648
    buffer_load_dwordx4 v9, s[32:35], s58 offen offset:1024 sc1 lds
    s_waitcnt lgkmcnt(6)
    v_mfma_f32_32x32x16_bf16 v[34:49], v[52:55], v[232:235], v[34:49]
    ds_read_b128 v[52:55], v6 offset:28672
    buffer_load_dwordx4 v9, s[32:35], s58 offen offset:2048 sc1 lds
    s_waitcnt lgkmcnt(6)
    v_mfma_f32_32x32x16_bf16 v[18:33], v[56:59], v[236:239], v[18:33]
    ds_read_b128 v[232:235], v6 offset:29696
    buffer_load_dwordx4 v9, s[32:35], s58 offen offset:3072 sc1 lds
    s_waitcnt lgkmcnt(6)
    v_mfma_f32_32x32x16_bf16 v[34:49], v[224:227], v[236:239], v[34:49]
    ds_read_b128 v[56:59], v6 offset:30720
    s_lshl_b32 s58, s40, 13
    s_add_u32 m0, s58, 69632
    s_add_u32 s58, s58, 20480
    buffer_load_dwordx4 v9, s[32:35], s58 offen offset:0 sc1 lds
    s_waitcnt lgkmcnt(6)
    v_mfma_f32_32x32x16_bf16 v[18:33], v[60:63], v[240:243], v[18:33]
    ds_read_b128 v[224:227], v6 offset:31744
    buffer_load_dwordx4 v9, s[32:35], s58 offen offset:1024 sc1 lds
    s_waitcnt lgkmcnt(6)
    v_mfma_f32_32x32x16_bf16 v[34:49], v[64:67], v[240:243], v[34:49]
    ds_read_b128 v[60:63], v6 offset:16384
    buffer_load_dwordx4 v9, s[32:35], s58 offen offset:2048 sc1 lds
    s_waitcnt lgkmcnt(6)
    v_mfma_f32_32x32x16_bf16 v[18:33], v[228:231], v[244:247], v[18:33]
    ds_read_b128 v[64:67], v6 offset:17408
    buffer_load_dwordx4 v9, s[32:35], s58 offen offset:3072 sc1 lds
    s_waitcnt lgkmcnt(6)
    v_mfma_f32_32x32x16_bf16 v[34:49], v[68:71], v[244:247], v[34:49]
    ds_read_b128 v[68:71], v6 offset:18432
    s_waitcnt lgkmcnt(6)
    v_mfma_f32_32x32x16_bf16 v[18:33], v[52:55], v[248:251], v[18:33]
    ds_read_b128 v[52:55], v6 offset:19456
    s_waitcnt lgkmcnt(6)
    v_mfma_f32_32x32x16_bf16 v[34:49], v[232:235], v[248:251], v[34:49]
    s_waitcnt lgkmcnt(5)
    v_mfma_f32_32x32x16_bf16 v[18:33], v[56:59], v[252:255], v[18:33]
    ds_read_b128 v[56:59], v6 offset:20480
    s_waitcnt lgkmcnt(5)
    v_mfma_f32_32x32x16_bf16 v[34:49], v[224:227], v[252:255], v[34:49]
    s_waitcnt lgkmcnt(4)
    v_mfma_f32_32x32x16_bf16 v[224:239], v[60:63], v[128:131], 0
    ds_read_b128 v[60:63], v6 offset:21504
    s_waitcnt lgkmcnt(4)
    v_mfma_f32_32x32x16_bf16 v[240:255], v[64:67], v[128:131], 0
    ds_read_b128 v[64:67], v6 offset:22528
    ds_read_b128 v[128:131], v6 offset:23552
    s_waitcnt lgkmcnt(5)
    v_mfma_f32_32x32x16_bf16 v[224:239], v[68:71], v[132:135], v[224:239]
    ds_read_b128 v[68:71], v6 offset:24576
    s_waitcnt lgkmcnt(5)
    v_mfma_f32_32x32x16_bf16 v[240:255], v[52:55], v[132:135], v[240:255]
    ds_read_b128 v[52:55], v6 offset:25600
    ds_read_b128 v[132:135], v6 offset:26624
    s_waitcnt lgkmcnt(6)
    v_mfma_f32_32x32x16_bf16 v[224:239], v[56:59], v[136:139], v[224:239]
    ds_read_b128 v[56:59], v6 offset:27648
    s_waitcnt lgkmcnt(6)
    v_mfma_f32_32x32x16_bf16 v[240:255], v[60:63], v[136:139], v[240:255]
    ds_read_b128 v[60:63], v6 offset:28672
    s_waitcnt vmcnt(0)
    ds_write_b32 v50, v9
    s_waitcnt lgkmcnt(7)
    v_mfma_f32_32x32x16_bf16 v[224:239], v[64:67], v[140:143], v[224:239]
    ds_read_b128 v[136:139], v6 offset:29696
    s_waitcnt lgkmcnt(7)
    v_mfma_f32_32x32x16_bf16 v[240:255], v[128:131], v[140:143], v[240:255]
    ds_read_b128 v[64:67], v6 offset:30720
    s_waitcnt lgkmcnt(7)
    v_mfma_f32_32x32x16_bf16 v[224:239], v[68:71], v[144:147], v[224:239]
    ds_read_b128 v[128:131], v6 offset:31744
    s_waitcnt lgkmcnt(7)
    v_mfma_f32_32x32x16_bf16 v[240:255], v[52:55], v[144:147], v[240:255]
    s_waitcnt lgkmcnt(6)
    v_mfma_f32_32x32x16_bf16 v[224:239], v[132:135], v[148:151], v[224:239]
L_cchk:
    ds_read_b32 v8, v51
    s_waitcnt lgkmcnt(0)
    v_cmp_eq_u32 vcc, 0, v8
    s_cbranch_vccnz L_cslow
    ds_read_b128 v[140:143], v7 offset:0
    ds_read_b128 v[68:71], v7 offset:1024
    ds_read_b128 v[52:55], v7 offset:2048
    ds_read_b128 v[144:147], v7 offset:3072
    v_mfma_f32_32x32x16_bf16 v[240:255], v[56:59], v[148:151], v[240:255]
    ds_read_b128 v[132:135], v7 offset:4096
    v_mfma_f32_32x32x16_bf16 v[224:239], v[60:63], v[152:155], v[224:239]
    ds_read_b128 v[56:59], v7 offset:5120
    v_mfma_f32_32x32x16_bf16 v[240:255], v[136:139], v[152:155], v[240:255]
    v_mfma_f32_32x32x16_bf16 v[224:239], v[64:67], v[156:159], v[224:239]
    ds_read_b128 v[148:151], v7 offset:6144
    v_mfma_f32_32x32x16_bf16 v[240:255], v[128:131], v[156:159], v[240:255]
    s_waitcnt lgkmcnt(6)
    v_mfma_f32_32x32x16_bf16 v[18:33], v[140:143], v[72:75], v[18:33]
    ds_read_b128 v[60:63], v7 offset:7168
    v_mfma_f32_32x32x16_bf16 v[224:239], v[140:143], v[160:163], v[224:239]
    s_waitcnt lgkmcnt(6)
    v_mfma_f32_32x32x16_bf16 v[34:49], v[68:71], v[72:75], v[34:49]
    ds_read_b128 v[136:139], v7 offset:8192
    v_mfma_f32_32x32x16_bf16 v[240:255], v[68:71], v[160:163], v[240:255]
    s_waitcnt lgkmcnt(6)
    v_mfma_f32_32x32x16_bf16 v[18:33], v[52:55], v[76:79], v[18:33]
    ds_read_b128 v[152:155], v7 offset:9216
    v_mfma_f32_32x32x16_bf16 v[224:239], v[52:55], v[164:167], v[224:239]
    s_waitcnt lgkmcnt(6)
    v_mfma_f32_32x32x16_bf16 v[34:49], v[144:147], v[76:79], v[34:49]
    ds_read_b128 v[64:67], v7 offset:10240
    v_mfma_f32_32x32x16_bf16 v[240:255], v[144:147], v[164:167], v[240:255]
    s_waitcnt lgkmcnt(6)
    v_mfma_f32_32x32x16_bf16 v[18:33], v[132:135], v[80:83], v[18:33]
    ds_read_b128 v[128:131], v7 offset:11264
    v_mfma_f32_32x32x16_bf16 v[224:239], v[132:135], v[168:171], v[224:239]
    s_waitcnt lgkmcnt(6)
    v_mfma_f32_32x32x16_bf16 v[34:49], v[56:59], v[80:83], v[34:49]
    ds_read_b128 v[156:159], v7 offset:12288
    v_mfma_f32_32x32x16_bf16 v[240:255], v[56:59], v[168:171], v[240:255]
    s_waitcnt lgkmcnt(6)
    v_mfma_f32_32x32x16_bf16 v[18:33], v[148:151], v[84:87], v[18:33]
    ds_read_b128 v[140:143], v7 offset:13312
    v_mfma_f32_32x32x16_bf16 v[224:239], v[148:151], v[172:175], v[224:239]
    s_waitcnt lgkmcnt(6)
    v_mfma_f32_32x32x16_bf16 v[34:49], v[60:63], v[84:87], v[34:49]
    ds_read_b128 v[68:71], v7 offset:14336
    v_mfma_f32_32x32x16_bf16 v[240:255], v[60:63], v[172:175], v[240:255]
    s_waitcnt lgkmcnt(6)
    v_mfma_f32_32x32x16_bf16 v[18:33], v[136:139], v[88:91], v[18:33]
    ds_read_b128 v[52:55], v7 offset:15360
    v_mfma_f32_32x32x16_bf16 v[224:239], v[136:139], v[176:179], v[224:239]
    s_waitcnt lgkmcnt(6)
    v_mfma_f32_32x32x16_bf16 v[34:49], v[152:155], v[88:91], v[34:49]
    ds_read_b128 v[144:147], v7 offset:16384
    v_mfma_f32_32x32x16_bf16 v[240:255], v[152:155], v[176:179], v[240:255]
    s_waitcnt lgkmcnt(6)
    v_mfma_f32_32x32x16_bf16 v[18:33], v[64:67], v[92:95], v[18:33]
    ds_read_b128 v[132:135], v7 offset:17408
    v_mfma_f32_32x32x16_bf16 v[224:239], v[64:67], v[180:183], v[224:239]
    s_waitcnt lgkmcnt(6)
    v_mfma_f32_32x32x16_bf16 v[34:49], v[128:131], v[92:95], v[34:49]
    ds_read_b128 v[56:59], v7 offset:18432
    v_mfma_f32_32x32x16_bf16 v[240:255], v[128:131], v[180:183], v[240:255]
    s_waitcnt lgkmcnt(6)
    v_mfma_f32_32x32x16_bf16 v[18:33], v[156:159], v[96:99], v[18:33]
    ds_read_b128 v[148:151], v7 offset:19456
    v_mfma_f32_32x32x16_bf16 v[224:239], v[156:159], v[184:187], v[224:239]
    s_waitcnt lgkmcnt(6)
    v_mfma_f32_32x32x16_bf16 v[34:49], v[140:143], v[96:99], v[34:49]
    ds_read_b128 v[60:63], v7 offset:20480
    v_mfma_f32_32x32x16_bf16 v[240:255], v[140:143], v[184:187], v[240:255]
    s_waitcnt lgkmcnt(6)
    v_mfma_f32_32x32x16_bf16 v[18:33], v[68:71], v[100:103], v[18:33]
    ds_read_b128 v[136:139], v7 offset:21504
    v_mfma_f32_32x32x16_bf16 v[224:239], v[68:71], v[188:191], v[224:239]
    s_waitcnt lgkmcnt(6)
    v_mfma_f32_32x32x16_bf16 v[34:49], v[52:55], v[100:103], v[34:49]
    ds_read_b128 v[152:155], v7 offset:22528
    v_mfma_f32_32x32x16_bf16 v[240:255], v[52:55], v[188:191], v[240:255]
    s_waitcnt lgkmcnt(6)
    v_mfma_f32_32x32x16_bf16 v[18:33], v[144:147], v[104:107], v[18:33]
    ds_read_b128 v[64:67], v7 offset:23552
    v_mfma_f32_32x32x16_bf16 v[224:239], v[144:147], v[192:195], v[224:239]
    s_waitcnt lgkmcnt(6)
    v_mfma_f32_32x32x16_bf16 v[34:49], v[132:135], v[104:107], v[34:49]
    ds_read_b128 v[128:131], v7 offset:24576
    v_mfma_f32_32x32x16_bf16 v[240:255], v[132:135], v[192:195], v[240:255]
    s_waitcnt lgkmcnt(6)
    v_mfma_f32_32x32x16_bf16 v[18:33], v[56:59], v[108:111], v[18:33]
    ds_read_b128 v[156:159], v7 offset:25600
    v_mfma_f32_32x32x16_bf16 v[224:239], v[56:59], v[196:199], v[224:239]
    s_waitcnt lgkmcnt(6)
    v_mfma_f32_32x32x16_bf16 v[34:49], v[148:151], v[108:111], v[34:49]
    ds_read_b128 v[140:143], v7 offset:26624
    v_mfma_f32_32x32x16_bf16 v[240:255], v[148:151], v[196:199], v[240:255]
    s_waitcnt lgkmcnt(6)
    v_mfma_f32_32x32x16_bf16 v[18:33], v[60:63], v[112:115], v[18:33]
    ds_read_b128 v[68:71], v7 offset:27648
    v_mfma_f32_32x32x16_bf16 v[224:239], v[60:63], v[200:203], v[224:239]
    s_waitcnt lgkmcnt(6)
    v_mfma_f32_32x32x16_bf16 v[34:49], v[136:139], v[112:115], v[34:49]
    ds_read_b128 v[52:55], v7 offset:28672
    buffer_load_dwordx2 v[2:3], v4, s[28:31], s62 offen sc1
    v_mfma_f32_32x32x16_bf16 v[240:255], v[136:139], v[200:203], v[240:255]
    s_waitcnt lgkmcnt(6)
    v_mfma_f32_32x32x16_bf16 v[18:33], v[152:155], v[116:119], v[18:33]
    ds_read_b128 v[144:147], v7 offset:29696
    v_mfma_f32_32x32x16_bf16 v[224:239], v[152:155], v[204:207], v[224:239]
    s_waitcnt lgkmcnt(6)
    v_mfma_f32_32x32x16_bf16 v[34:49], v[64:67], v[116:119], v[34:49]
    v_mfma_f32_32x32x16_bf16 v[240:255], v[64:67], v[204:207], v[240:255]
    s_waitcnt lgkmcnt(5)
    v_mfma_f32_32x32x16_bf16 v[18:33], v[128:131], v[120:123], v[18:33]
    v_mfma_f32_32x32x16_bf16 v[224:239], v[128:131], v[208:211], v[224:239]
    s_waitcnt lgkmcnt(4)
    v_mfma_f32_32x32x16_bf16 v[34:49], v[156:159], v[120:123], v[34:49]
    v_mfma_f32_32x32x16_bf16 v[240:255], v[156:159], v[208:211], v[240:255]
    s_waitcnt lgkmcnt(3)
    v_mfma_f32_32x32x16_bf16 v[18:33], v[140:143], v[124:127], v[18:33]
    v_mfma_f32_32x32x16_bf16 v[224:239], v[140:143], v[212:215], v[224:239]
    s_waitcnt lgkmcnt(2)
    v_mfma_f32_32x32x16_bf16 v[34:49], v[68:71], v[124:127], v[34:49]
    buffer_load_dwordx2 v[50:51], v4, s[28:31], s62 offen sc1
    v_mfma_f32_32x32x16_bf16 v[240:255], v[68:71], v[212:215], v[240:255]
    s_waitcnt lgkmcnt(1)
    v_mfma_f32_32x32x16_bf16 v[34:49], v[52:55], v[10:13], v[34:49]
    v_mfma_f32_32x32x16_bf16 v[240:255], v[52:55], v[216:219], v[240:255]
    s_waitcnt lgkmcnt(0)
    v_mfma_f32_32x32x16_bf16 v[34:49], v[144:147], v[14:17], v[34:49]
    v_mfma_f32_32x32x16_bf16 v[240:255], v[144:147], v[220:223], v[240:255]
    s_nop 10
    v_mul_f32 v8, v18, v34
    v_mul_f32 v14, v19, v35
    v_fmac_f32 v8, v20, v36
    v_fmac_f32 v14, v21, v37
    v_fmac_f32 v8, v22, v38
    v_fmac_f32 v14, v23, v39
    v_fmac_f32 v8, v24, v40
    v_fmac_f32 v14, v25, v41
    v_fmac_f32 v8, v26, v42
    v_fmac_f32 v14, v27, v43
    v_fmac_f32 v8, v28, v44
    v_fmac_f32 v14, v29, v45
    v_fmac_f32 v8, v30, v46
    v_fmac_f32 v14, v31, v47
    v_fmac_f32 v8, v32, v48
    v_fmac_f32 v14, v33, v49
    v_mul_f32 v9, v224, v240
    v_mul_f32 v15, v225, v241
    v_fmac_f32 v9, v226, v242
    v_fmac_f32 v15, v227, v243
    v_fmac_f32 v9, v228, v244
    v_fmac_f32 v15, v229, v245
    v_fmac_f32 v9, v230, v246
    v_fmac_f32 v15, v231, v247
    v_fmac_f32 v9, v232, v248
    v_fmac_f32 v15, v233, v249
    v_fmac_f32 v9, v234, v250
    v_fmac_f32 v15, v235, v251
    v_fmac_f32 v9, v236, v252
    v_fmac_f32 v15, v237, v253
    v_fmac_f32 v9, v238, v254
    v_fmac_f32 v15, v239, v255
    v_add_f32 v8, v8, v14
    v_add_f32 v9, v9, v15
    v_add_f32 v8, v8, v9
    v_mov_b32 v9, s27
    s_mov_b32 s58, 0x3ffffff
    s_waitcnt vmcnt(1)
    v_cmp_ne_u32 vcc, v9, v3
    s_nop 0
    s_and_b32 vcc_lo, vcc_lo, s58
    s_cbranch_scc1 L_secondC
L_ok0C:
    v_add_f32 v8, v8, v2
L_okC:
    s_nop 1
    v_add_f32_dpp v8, v8, v8 row_shr:1 row_mask:0xf bank_mask:0xf bound_ctrl:1
    s_nop 1
    v_add_f32_dpp v8, v8, v8 row_shr:2 row_mask:0xf bank_mask:0xf bound_ctrl:1
    s_nop 1
    v_add_f32_dpp v8, v8, v8 row_shr:4 row_mask:0xf bank_mask:0xf bound_ctrl:1
    s_nop 1
    v_add_f32_dpp v8, v8, v8 row_shr:8 row_mask:0xf bank_mask:0xf bound_ctrl:1
    s_nop 1
    v_add_f32_dpp v8, v8, v8 row_bcast:15 row_mask:0xa bank_mask:0xf
    s_nop 1
    v_add_f32_dpp v8, v8, v8 row_bcast:31 row_mask:0xc bank_mask:0xf
    v_add_f32 v8, s63, v8
    v_cmp_eq_u32 vcc, 63, v1
    v_cvt_pk_bf16_f32 v8, v8, v8
    s_nop 0
    v_cndmask_b32 v5, v5, 0, vcc
    buffer_store_short v8, v5, s[88:91], s61 offen
    s_endpgm
L_secondC:
    s_waitcnt vmcnt(0)
    v_mov_b32 v2, v50
    v_cmp_ne_u32 vcc, v9, v51
    s_nop 0
    s_and_b32 vcc_lo, vcc_lo, s58
    s_cbranch_scc0 L_ok0C
L_slowC:
    s_sub_u32 s92, s92, 1
    s_cbranch_scc1 L_exit
    s_mov_b32 exec_lo, vcc_lo
    s_mov_b32 exec_hi, 0
    buffer_load_dwordx2 v[2:3], v4, s[28:31], s62 offen sc1
    s_waitcnt vmcnt(0)
    v_cmp_ne_u32 vcc, v9, v3
    s_nop 0
    s_and_b32 vcc_lo, vcc_lo, s58
    s_cbranch_scc1 L_slowC
    s_mov_b64 exec, -1
    s_branch L_ok0C
L_cslow:
    s_sub_u32 s92, s92, 1
    s_cbranch_scc1 L_exit
    s_branch L_cchk
L_cwslow:
    s_sub_u32 s92, s92, 1
    s_cbranch_scc1 L_exit
    s_sleep 2
    global_load_dwordx2 v[2:3], v7, s[22:23] sc1
    global_load_dword v6, v8, s[24:25] sc1
    s_waitcnt vmcnt(0)
    s_branch L_cwchk
L_helper:
    s_sub_u32 s45, s43, 26
    s_lshl_b32 s40, s45, 3
    s_add_u32 s40, s40, s41
    s_lshl_b32 s84, s41, 5
    s_add_u32 s84, s84, s43
    s_cmp_lt_u32 s40, 13
    s_cbranch_scc1 L_prep
    s_cmp_lt_u32 s45, 2
    s_cbranch_scc1 L_pfdone
    s_cmp_lt_u32 s86, 4
    s_cbranch_scc1 L_noadd
    v_lshrrev_b32 v10, 3, v1
    v_and_b32 v11, 7, v1
    v_lshlrev_b32 v11, 4, v11
    s_and_b32 s59, s86, 3
    s_lshl_b32 s59, s59, 3
    v_add_u32 v10, s59, v10
    v_mul_u32_u24 v10, 3328, v10
    v_add_u32 v8, v10, v11
    v_add_u32 v9, 2768896, v8
    s_add_u32 s47, s46, 26
    s_add_u32 s46, s46, s45
    s_and_b32 s59, s86, 0
    s_add_u32 s46, s46, s59
    s_sub_u32 s46, s46, 2
    s_mov_b32 s38, 5537792
    s_mov_b32 s39, 0x20000
    s_waitcnt lgkmcnt(0)
    s_mov_b32 s36, s12
    s_mov_b32 s37, s13
    s_and_b32 s58, s46, 7
    s_mul_i32 s58, s58, 12
    s_lshr_b32 s58, s58, 3
    s_mul_i32 s58, s58, 212992
    s_lshr_b32 s59, s46, 3
    s_lshl_b32 s59, s59, 7
    s_add_u32 s48, s58, s59
    s_cmp_lt_u32 s46, s47
    s_cselect_b32 s48, s48, 0x7ff00000
    s_add_u32 s46, s46, 4
    buffer_load_dwordx4 v[16:19], v8, s[36:39], s48 offen
    buffer_load_dwordx4 v[20:23], v9, s[36:39], s48 offen
    s_and_b32 s58, s46, 7
    s_mul_i32 s58, s58, 12
    s_lshr_b32 s58, s58, 3
    s_mul_i32 s58, s58, 212992
    s_lshr_b32 s59, s46, 3
    s_lshl_b32 s59, s59, 7
    s_add_u32 s49, s58, s59
    s_cmp_lt_u32 s46, s47
    s_cselect_b32 s49, s49, 0x7ff00000
    s_add_u32 s46, s46, 4
    buffer_load_dwordx4 v[24:27], v8, s[36:39], s49 offen
    buffer_load_dwordx4 v[28:31], v9, s[36:39], s49 offen
    s_and_b32 s58, s46, 7
    s_mul_i32 s58, s58, 12
    s_lshr_b32 s58, s58, 3
    s_mul_i32 s58, s58, 212992
    s_lshr_b32 s59, s46, 3
    s_lshl_b32 s59, s59, 7
    s_add_u32 s50, s58, s59
    s_cmp_lt_u32 s46, s47
    s_cselect_b32 s50, s50, 0x7ff00000
    s_add_u32 s46, s46, 4
    buffer_load_dwordx4 v[32:35], v8, s[36:39], s50 offen
    buffer_load_dwordx4 v[36:39], v9, s[36:39], s50 offen
    s_and_b32 s58, s46, 7
    s_mul_i32 s58, s58, 12
    s_lshr_b32 s58, s58, 3
    s_mul_i32 s58, s58, 212992
    s_lshr_b32 s59, s46, 3
    s_lshl_b32 s59, s59, 7
    s_add_u32 s51, s58, s59
    s_cmp_lt_u32 s46, s47
    s_cselect_b32 s51, s51, 0x7ff00000
    s_add_u32 s46, s46, 4
    buffer_load_dwordx4 v[40:43], v8, s[36:39], s51 offen
    buffer_load_dwordx4 v[44:47], v9, s[36:39], s51 offen
    s_and_b32 s58, s46, 7
    s_mul_i32 s58, s58, 12
    s_lshr_b32 s58, s58, 3
    s_mul_i32 s58, s58, 212992
    s_lshr_b32 s59, s46, 3
    s_lshl_b32 s59, s59, 7
    s_add_u32 s52, s58, s59
    s_cmp_lt_u32 s46, s47
    s_cselect_b32 s52, s52, 0x7ff00000
    s_add_u32 s46, s46, 4
    buffer_load_dwordx4 v[48:51], v8, s[36:39], s52 offen
    buffer_load_dwordx4 v[52:55], v9, s[36:39], s52 offen
    s_and_b32 s58, s46, 7
    s_mul_i32 s58, s58, 12
    s_lshr_b32 s58, s58, 3
    s_mul_i32 s58, s58, 212992
    s_lshr_b32 s59, s46, 3
    s_lshl_b32 s59, s59, 7
    s_add_u32 s53, s58, s59
    s_cmp_lt_u32 s46, s47
    s_cselect_b32 s53, s53, 0x7ff00000
    s_add_u32 s46, s46, 4
    buffer_load_dwordx4 v[56:59], v8, s[36:39], s53 offen
    buffer_load_dwordx4 v[60:63], v9, s[36:39], s53 offen
    s_and_b32 s58, s46, 7
    s_mul_i32 s58, s58, 12
    s_lshr_b32 s58, s58, 3
    s_mul_i32 s58, s58, 212992
    s_lshr_b32 s59, s46, 3
    s_lshl_b32 s59, s59, 7
    s_add_u32 s54, s58, s59
    s_cmp_lt_u32 s46, s47
    s_cselect_b32 s54, s54, 0x7ff00000
    s_add_u32 s46, s46, 4
    buffer_load_dwordx4 v[64:67], v8, s[36:39], s54 offen
    buffer_load_dwordx4 v[68:71], v9, s[36:39], s54 offen
    s_add_u32 s48, s48, 106496
    buffer_load_dwordx4 v[72:75], v8, s[36:39], s48 offen
    buffer_load_dwordx4 v[76:79], v9, s[36:39], s48 offen
    s_add_u32 s49, s49, 106496
    buffer_load_dwordx4 v[80:83], v8, s[36:39], s49 offen
    buffer_load_dwordx4 v[84:87], v9, s[36:39], s49 offen
    s_add_u32 s50, s50, 106496
    buffer_load_dwordx4 v[88:91], v8, s[36:39], s50 offen
    buffer_load_dwordx4 v[92:95], v9, s[36:39], s50 offen
    s_add_u32 s51, s51, 106496
    buffer_load_dwordx4 v[96:99], v8, s[36:39], s51 offen
    buffer_load_dwordx4 v[100:103], v9, s[36:39], s51 offen
    s_add_u32 s52, s52, 106496
    buffer_load_dwordx4 v[104:107], v8, s[36:39], s52 offen
    buffer_load_dwordx4 v[108:111], v9, s[36:39], s52 offen
    s_add_u32 s53, s53, 106496
    buffer_load_dwordx4 v[112:115], v8, s[36:39], s53 offen
    buffer_load_dwordx4 v[116:119], v9, s[36:39], s53 offen
    s_add_u32 s54, s54, 106496
    buffer_load_dwordx4 v[120:123], v8, s[36:39], s54 offen
    buffer_load_dwordx4 v[124:127], v9, s[36:39], s54 offen
    s_add_u32 s48, s48, 106496
    buffer_load_dwordx4 v[128:131], v8, s[36:39], s48 offen
    buffer_load_dwordx4 v[132:135], v9, s[36:39], s48 offen
    s_add_u32 s49, s49, 106496
    buffer_load_dwordx4 v[136:139], v8, s[36:39], s49 offen
    buffer_load_dwordx4 v[140:143], v9, s[36:39], s49 offen
    s_add_u32 s50, s50, 106496
    buffer_load_dwordx4 v[16:19], v8, s[36:39], s50 offen
    buffer_load_dwordx4 v[20:23], v9, s[36:39], s50 offen
    s_add_u32 s51, s51, 106496
    buffer_load_dwordx4 v[24:27], v8, s[36:39], s51 offen
    buffer_load_dwordx4 v[28:31], v9, s[36:39], s51 offen
    s_add_u32 s52, s52, 106496
    buffer_load_dwordx4 v[32:35], v8, s[36:39], s52 offen
    buffer_load_dwordx4 v[36:39], v9, s[36:39], s52 offen
    s_add_u32 s53, s53, 106496
    buffer_load_dwordx4 v[40:43], v8, s[36:39], s53 offen
    buffer_load_dwordx4 v[44:47], v9, s[36:39], s53 offen
    s_add_u32 s54, s54, 106496
    buffer_load_dwordx4 v[48:51], v8, s[36:39], s54 offen
    buffer_load_dwordx4 v[52:55], v9, s[36:39], s54 offen
    s_sub_u32 s58, s47, 26
    s_or_b32 s58, s58, 7
    s_sub_u32 s59, s45, 2
    s_lshl_b32 s59, s59, 3
    s_add_u32 s58, s58, s59
    s_lshr_b32 s59, s58, 3
    s_lshl_b32 s59, s59, 7
    s_add_u32 s59, s59, 2449408
    s_cmp_lt_u32 s58, s47
    s_cselect_b32 s59, s59, 0x7ff00000
    buffer_load_dwordx4 v[56:59], v8, s[36:39], s59 offen
    buffer_load_dwordx4 v[60:63], v9, s[36:39], s59 offen
    s_add_u32 s59, s59, 106496
    buffer_load_dwordx4 v[64:67], v8, s[36:39], s59 offen
    buffer_load_dwordx4 v[68:71], v9, s[36:39], s59 offen
    s_add_u32 s59, s59, 106496
    buffer_load_dwordx4 v[72:75], v8, s[36:39], s59 offen
    buffer_load_dwordx4 v[76:79], v9, s[36:39], s59 offen
    s_add_u32 s59, s59, 106496
L_pfdone:
    s_cmp_lt_u32 s86, 4
    s_cbranch_scc1 L_noadd
    s_endpgm
L_prep:
    s_waitcnt lgkmcnt(0)
    s_load_dword s27, s[24:25], 61440
    s_lshr_b32 s41, s86, 2
    s_and_b32 s42, s86, 3
    s_mul_i32 s43, s41, 13
    s_add_u32 s43, s43, s40
    s_lshl_b32 s44, s41, 14
    s_add_u32 s44, s44, 49152
    v_and_b32 v2, 255, v0
    v_lshlrev_b32 v9, 4, v1
    v_mov_b32 v7, 2147483647
    s_mov_b32 s28, s8
    s_mov_b32 s29, s9
    s_mov_b32 s30, 105456
    s_mov_b32 s31, 0x20000
    s_lshl_b32 s45, s86, 10
    s_add_u32 s46, s45, 70304
    s_add_u32 m0, s45, 0
    s_nop 0
    buffer_load_dwordx4 v9, s[28:31], s46 offen lds
    s_add_u32 s46, s46, 8192
    s_add_u32 m0, s45, 8192
    s_nop 0
    buffer_load_dwordx4 v9, s[28:31], s46 offen lds
    s_add_u32 s46, s46, 8192
    s_add_u32 m0, s45, 16384
    s_nop 0
    buffer_load_dwordx4 v9, s[28:31], s46 offen lds
    s_add_u32 s46, s46, 8192
    s_add_u32 m0, s45, 24576
    s_nop 0
    buffer_load_dwordx4 v9, s[28:31], s46 offen lds
    s_add_u32 s46, s46, 8192
    s_add_u32 m0, s45, 32768
    s_nop 0
    buffer_load_dwordx4 v9, s[28:31], s46 offen lds
    s_add_u32 s46, s46, 8192
    s_cmp_ge_u32 s86, 3
    s_cbranch_scc1 L_p_skip
    s_add_u32 m0, s45, 40960
    s_nop 0
    buffer_load_dwordx4 v9, s[28:31], s46 offen lds
L_p_skip:
    s_mov_b32 s36, s10
    s_mov_b32 s37, s11
    s_mov_b32 s38, 156
    s_mov_b32 s39, 0x20000
    v_lshrrev_b32 v3, 5, v1
    v_lshlrev_b32 v4, 4, v3
    buffer_load_dwordx4 v[16:19], v4, s[36:39], 0 offen offset:104
    buffer_load_dwordx4 v[20:23], v4, s[36:39], 0 offen offset:136
    s_movk_i32 s62, 5042
    s_mul_i32 s47, s43, 52
    s_add_u32 s47, s47, 35152
    s_lshl_b32 s48, s42, 8
    s_add_u32 s48, s48, s44
    v_add_u32 v5, 0, v2
    v_mul_lo_u32 v6, v5, s62
    v_lshrrev_b32 v6, 16, v6
    v_mul_u32_u24 v8, 1300, v6
    v_lshl_add_u32 v8, v5, 2, v8
    v_cmp_gt_u32 vcc, 338, v5
    s_nop 1
    v_cndmask_b32 v8, v7, v8, vcc
    s_add_u32 m0, s48, 0
    s_nop 0
    buffer_load_dword v8, s[28:31], s47 offen lds
    v_add_u32 v5, 256, v2
    v_mul_lo_u32 v6, v5, s62
    v_lshrrev_b32 v6, 16, v6
    v_mul_u32_u24 v8, 1300, v6
    v_lshl_add_u32 v8, v5, 2, v8
    v_cmp_gt_u32 vcc, 338, v5
    s_nop 1
    v_cndmask_b32 v8, v7, v8, vcc
    s_add_u32 m0, s48, 1024
    s_nop 0
    buffer_load_dword v8, s[28:31], s47 offen lds
    v_lshlrev_b32 v6, 3, v2
    v_cmp_gt_u32 vcc, 169, v2
    s_nop 1
    v_cndmask_b32 v6, v7, v6, vcc
    s_mul_i32 s58, s43, 1352
    buffer_load_dwordx2 v[68:69], v6, s[28:31], s58 offen
    v_lshlrev_b32 v80, 1, v2
    v_add_u32 v80, 52, v80
    v_cmp_gt_u32 vcc, 26, v2
    s_nop 1
    v_cndmask_b32 v80, v7, v80, vcc
    v_mov_b32 v81, 0
    v_mov_b32 v82, 0
    v_mov_b32 v83, 0
    buffer_load_short_d16_hi v81, v80, s[36:39], 0 offen
    s_lshl_b32 s61, s43, 1
    buffer_load_short_d16_hi v82, v83, s[36:39], s61 offen
    s_or_b32 s58, s40, s86
    s_cmp_eq_u32 s58, 0
    s_cbranch_scc0 L_notag
    s_waitcnt lgkmcnt(0)
    s_add_u32 s27, s27, 1
    v_mov_b32 v108, 0
    v_mov_b32 v110, 1
    v_mov_b32 v111, s27
    v_mov_b32 v109, 61440
    global_store_dwordx2 v108, v[110:111], s[22:23] sc0 sc1
    global_store_dword v109, v111, s[24:25] sc0 sc1
L_notag:
    s_mov_b32 s32, s24
    s_mov_b32 s33, s25
    s_mov_b32 s34, 47104
    s_mov_b32 s35, 0x20000
    v_and_b32 v101, 127, v2
    v_and_b32 v10, 1, v2
    v_subrev_u32 v5, 44, v101
    v_lshrrev_b32 v5, 1, v5
    v_lshl_add_u32 v6, v5, 1, 1
    v_add_u32 v8, 22, v5
    v_cmp_gt_u32 vcc, 22, v5
    s_nop 1
    v_cndmask_b32 v6, v8, v6, vcc
    v_and_b32 v8, 0xfffe, v101
    v_cmp_gt_u32 vcc, 44, v101
    s_nop 1
    v_cndmask_b32 v6, v6, v8, vcc
    v_lshlrev_b32 v6, 10, v6
    v_lshl_add_u32 v6, v10, 9, v6
    s_lshl_b32 s58, s43, 4
    v_add_u32 v103, s58, v6
    v_cmp_gt_u32 vcc, 92, v101
    s_nop 1
    v_cndmask_b32 v103, v7, v103, vcc
    v_add_u32 v102, 416, v103
    s_cmp_lt_u32 s43, 6
    s_cselect_b32 s58, 128, -1
    v_cmp_le_u32 vcc, s58, v2
    s_nop 1
    v_cndmask_b32 v102, v7, v102, vcc
    v_cmp_gt_u32 vcc, 128, v2
    s_nop 1
    v_cndmask_b32 v103, v7, v103, vcc
    v_mov_b32 v12, 0
    v_mov_b32 v13, 0
    v_mov_b32 v14, 0
    v_mov_b32 v15, 0
    buffer_store_dwordx4 v[12:15], v102, s[32:35], 0 offen sc0 sc1
    s_add_u32 s49, s44, 5120
    s_add_u32 s50, s44, 9216
    s_add_u32 s51, s44, 13312
    s_add_u32 s52, s51, 4
    v_mov_b32 v100, s52
    s_add_u32 s52, s50, 2704
    v_mov_b32 v90, v2
    v_mov_b32 v92, s49
    v_bfe_u32 v93, v90, 3, 1
    v_lshrrev_b32 v94, 4, v90
    v_and_b32 v95, 7, v90
    v_lshl_add_u32 v94, v94, 3, v95
    v_mul_lo_u32 v95, v94, s62
    v_lshrrev_b32 v95, 16, v95
    v_mul_u32_u24 v96, 13, v95
    v_sub_u32 v96, v94, v96
    v_lshl_add_u32 v96, v96, 1, v93
    v_add_u32 v97, v96, v95
    v_subrev_u32 v98, 26, v97
    v_min_u32 v97, v97, v98
    v_mad_u32_u24 v98, v96, 26, v97
    v_lshl_add_u32 v84, v98, 2, v92
    v_mad_u32_u24 v98, v97, 26, v96
    v_lshl_add_u32 v85, v98, 2, v92
    v_cmp_eq_u32 vcc, 0, v95
    s_nop 1
    v_cndmask_b32 v85, v85, v100, vcc
    v_add_u32 v90, 256, v2
    v_cmp_le_u32 vcc, 352, v90
    v_subrev_u32 v91, 352, v90
    s_nop 0
    v_cndmask_b32 v90, v90, v91, vcc
    v_mov_b32 v92, s49
    v_mov_b32 v93, s50
    v_cndmask_b32 v92, v92, v93, vcc
    v_bfe_u32 v93, v90, 3, 1
    v_lshrrev_b32 v94, 4, v90
    v_and_b32 v95, 7, v90
    v_lshl_add_u32 v94, v94, 3, v95
    v_mul_lo_u32 v95, v94, s62
    v_lshrrev_b32 v95, 16, v95
    v_mul_u32_u24 v96, 13, v95
    v_sub_u32 v96, v94, v96
    v_lshl_add_u32 v96, v96, 1, v93
    v_add_u32 v97, v96, v95
    v_subrev_u32 v98, 26, v97
    v_min_u32 v97, v97, v98
    v_mad_u32_u24 v98, v96, 26, v97
    v_lshl_add_u32 v86, v98, 2, v92
    v_mad_u32_u24 v98, v97, 26, v96
    v_lshl_add_u32 v87, v98, 2, v92
    v_cmp_eq_u32 vcc, 0, v95
    s_nop 1
    v_cndmask_b32 v87, v87, v100, vcc
    v_lshl_add_u32 v98, v94, 1, v93
    v_cmp_le_u32 vcc, 351, v98
    s_nop 1
    v_cndmask_b32 v86, v86, v100, vcc
    v_cndmask_b32 v87, v87, v100, vcc
    v_add_u32 v90, 160, v2
    v_mov_b32 v92, s50
    v_bfe_u32 v93, v90, 3, 1
    v_lshrrev_b32 v94, 4, v90
    v_and_b32 v95, 7, v90
    v_lshl_add_u32 v94, v94, 3, v95
    v_mul_lo_u32 v95, v94, s62
    v_lshrrev_b32 v95, 16, v95
    v_mul_u32_u24 v96, 13, v95
    v_sub_u32 v96, v94, v96
    v_lshl_add_u32 v96, v96, 1, v93
    v_add_u32 v97, v96, v95
    v_subrev_u32 v98, 26, v97
    v_min_u32 v97, v97, v98
    v_mad_u32_u24 v98, v96, 26, v97
    v_lshl_add_u32 v88, v98, 2, v92
    v_mad_u32_u24 v98, v97, 26, v96
    v_lshl_add_u32 v89, v98, 2, v92
    v_cmp_eq_u32 vcc, 0, v95
    s_nop 1
    v_cndmask_b32 v89, v89, v100, vcc
    v_lshl_add_u32 v98, v94, 1, v93
    v_cmp_le_u32 vcc, 351, v98
    s_nop 1
    v_cndmask_b32 v88, v88, v100, vcc
    v_cndmask_b32 v89, v89, v100, vcc
    v_subrev_u32 v99, 352, v98
    v_lshl_add_u32 v91, v99, 2, s52
    v_cmp_gt_u32 vcc, 26, v99
    s_nop 1
    v_cndmask_b32 v88, v88, v91, vcc
    v_mov_b32 v91, s51
    v_cmp_eq_u32 vcc, 26, v99
    s_nop 1
    v_cndmask_b32 v88, v88, v91, vcc
    v_bfe_u32 v5, v1, 2, 2
    v_lshl_add_u32 v5, v3, 3, v5
    v_mul_u32_u24 v5, 1352, v5
    v_bfe_u32 v6, v1, 4, 1
    v_lshl_add_u32 v5, v6, 5, v5
    v_and_b32 v6, 3, v1
    v_lshl_add_u32 v5, v6, 3, v5
    s_mul_i32 s58, s86, 192
    v_add_u32 v5, s58, v5
    s_mul_i32 s58, s86, 384
    s_add_u32 s58, s58, 45056
    v_and_b32 v6, 31, v1
    v_lshl_add_u32 v6, v6, 2, s58
    v_and_b32 v12, 15, v1
    v_lshrrev_b32 v14, 4, v1
    s_and_b32 s59, s42, 1
    s_lshl_b32 s59, s59, 4
    v_add_u32 v13, s59, v12
    s_lshr_b32 s59, s42, 1
    s_lshl_b32 s59, s59, 4
    s_waitcnt vmcnt(3)
    v_lshlrev_b32 v104, 16, v68
    v_and_b32 v105, 0xffff0000, v68
    v_lshlrev_b32 v106, 16, v69
    v_and_b32 v107, 0xffff0000, v69
    v_lshl_add_u32 v113, v2, 4, s44
    ds_write_b128 v113, v[104:107] offset:5120
    v_mul_u32_u24 v114, 104, v2
    v_mov_b32 v115, 13824
    v_cmp_gt_u32 vcc, 28, v2
    s_nop 1
    v_cndmask_b32 v114, v115, v114, vcc
    v_add_u32 v114, s44, v114
    s_waitcnt vmcnt(2)
    ds_write_b32 v114, v81 offset:2048
    v_mov_b32 v116, s51
    s_waitcnt vmcnt(1)
    ds_write_b64 v116, v[82:83]
    s_barrier
    ds_read_b64_tr_b16 v[24:25], v5 offset:0
    ds_read_b64_tr_b16 v[26:27], v5 offset:5408
    ds_read_b64_tr_b16 v[28:29], v5 offset:21632
    ds_read_b64_tr_b16 v[30:31], v5 offset:27040
    ds_read_b64_tr_b16 v[32:33], v5 offset:64
    ds_read_b64_tr_b16 v[34:35], v5 offset:5472
    ds_read_b64_tr_b16 v[36:37], v5 offset:21696
    ds_read_b64_tr_b16 v[38:39], v5 offset:27104
    ds_read_b64_tr_b16 v[40:41], v5 offset:128
    ds_read_b64_tr_b16 v[42:43], v5 offset:5536
    ds_read_b64_tr_b16 v[44:45], v5 offset:21760
    ds_read_b64_tr_b16 v[46:47], v5 offset:27168
    v_mad_u32_u24 v15, v14, 26, v13
    v_lshl_add_u32 v15, v15, 1, s44
    v_mov_b32 v72, 0
    v_mov_b32 v73, 0
    v_mov_b32 v74, 0
    v_mov_b32 v75, 0
    v_mov_b32 v76, 0
    v_mov_b32 v77, 0
    v_mov_b32 v78, 0
    ds_read_u16_d16_hi v72, v15 offset:0
    ds_read_u16_d16_hi v73, v15 offset:208
    ds_read_u16_d16_hi v74, v15 offset:416
    ds_read_u16_d16_hi v75, v15 offset:624
    ds_read_u16_d16_hi v76, v15 offset:832
    ds_read_u16_d16_hi v77, v15 offset:1040
    ds_read_u16_d16_hi v78, v15 offset:1248
    s_waitcnt lgkmcnt(15)
    v_mfma_f32_32x32x16_bf16 v[48:63], v[16:19], v[24:27], 0
    v_mfma_f32_32x32x16_bf16 v[48:63], v[20:23], v[28:31], v[48:63]
    s_waitcnt lgkmcnt(13)
    v_mfma_f32_32x32x16_bf16 v[120:135], v[16:19], v[32:35], 0
    s_waitcnt lgkmcnt(11)
    v_mfma_f32_32x32x16_bf16 v[120:135], v[20:23], v[36:39], v[120:135]
    s_waitcnt lgkmcnt(9)
    v_mfma_f32_32x32x16_bf16 v[136:151], v[16:19], v[40:43], 0
    s_waitcnt lgkmcnt(7)
    v_mfma_f32_32x32x16_bf16 v[136:151], v[20:23], v[44:47], v[136:151]
    v_add_u32 v117, s59, v12
    v_mad_u32_u24 v118, v14, 26, v117
    v_lshlrev_b32 v118, 2, v118
    v_add_u32 v118, 45056, v118
    v_mul_u32_u24 v119, 104, v14
    v_add_u32 v119, s44, v119
    v_add_u32 v119, 2048, v119
    v_cmp_gt_u32 vcc, 26, v117
    s_nop 1
    v_cndmask_b32 v119, v119, v118, vcc
    v_lshl_add_u32 v117, v14, 2, s59
    v_mad_u32_u24 v117, v117, 26, v13
    v_lshlrev_b32 v117, 2, v117
    v_mov_b32 v115, 6656
    v_cmp_gt_u32 vcc, 26, v13
    s_nop 1
    v_cndmask_b32 v117, v115, v117, vcc
    v_add_u32 v117, s44, v117
    ds_write_b32 v6, v48 offset:0
    ds_write_b32 v6, v120 offset:128
    ds_write_b32 v6, v136 offset:256
    s_waitcnt lgkmcnt(0)
    s_barrier
    v_mov_b32 v152, 0
    global_load_dwordx2 v[154:155], v152, s[22:23] sc1
    ds_read_b32 v16, v119 offset:0
    ds_read_b32 v17, v119 offset:416
    ds_read_b32 v18, v119 offset:832
    ds_read_b32 v19, v119 offset:1248
    ds_read_b32 v20, v119 offset:1664
    ds_read_b32 v21, v119 offset:2080
    ds_read_b32 v22, v119 offset:2496
    s_waitcnt lgkmcnt(6)
    v_mfma_f32_16x16x4_f32 v[32:35], v16, v72, 0
    s_waitcnt lgkmcnt(5)
    v_mfma_f32_16x16x4_f32 v[32:35], v17, v73, v[32:35]
    s_waitcnt lgkmcnt(4)
    v_mfma_f32_16x16x4_f32 v[32:35], v18, v74, v[32:35]
    s_waitcnt lgkmcnt(3)
    v_mfma_f32_16x16x4_f32 v[32:35], v19, v75, v[32:35]
    s_waitcnt lgkmcnt(2)
    v_mfma_f32_16x16x4_f32 v[32:35], v20, v76, v[32:35]
    s_waitcnt lgkmcnt(1)
    v_mfma_f32_16x16x4_f32 v[32:35], v21, v77, v[32:35]
    s_waitcnt lgkmcnt(0)
    v_mfma_f32_16x16x4_f32 v[32:35], v22, v78, v[32:35]
    v_lshl_add_u32 v112, v2, 1, s44
    s_nop 8
    ds_write_b32 v117, v32 offset:9216
    ds_write_b32 v117, v33 offset:9320
    ds_write_b32 v117, v34 offset:9424
    ds_write_b32 v117, v35 offset:9528
    s_waitcnt lgkmcnt(0)
    s_barrier
    ds_read_b32 v16, v84
    ds_read_b32 v17, v85
    ds_read_b32 v18, v86
    ds_read_b32 v19, v87
    ds_read_b32 v20, v88
    ds_read_b32 v21, v89
    s_waitcnt lgkmcnt(4)
    v_add_f32 v16, v16, v17
    v_cvt_pk_bf16_f32 v16, v16, v16
    ds_write_b16 v112, v16 offset:13568
    s_waitcnt lgkmcnt(3)
    v_add_f32 v18, v18, v19
    v_cvt_pk_bf16_f32 v18, v18, v18
    ds_write_b16 v112, v18 offset:14080
    s_waitcnt lgkmcnt(2)
    v_add_f32 v20, v20, v21
    v_cvt_pk_bf16_f32 v20, v20, v20
    ds_write_b16 v112, v20 offset:14592
    s_waitcnt lgkmcnt(0)
    s_barrier
    ds_read_b128 v[8:11], v113 offset:13568
    s_waitcnt lgkmcnt(0)
    buffer_store_dwordx4 v[8:11], v103, s[32:35], 0 offen sc0 sc1
    s_waitcnt vmcnt(0)
    s_barrier
    s_cmp_ge_u32 s86, 4
    s_cbranch_scc1 L_exit
    s_cmp_lg_u32 s86, 3
    s_cbranch_scc1 L_noadd
L_tagchk:
    v_readfirstlane_b32 s58, v154
    v_readfirstlane_b32 s27, v155
    s_cmp_lg_u32 s58, 0
    s_cbranch_scc1 L_tagok
    s_sub_u32 s92, s92, 1
    s_cbranch_scc1 L_exit
    global_load_dwordx2 v[154:155], v152, s[22:23] sc1
    s_waitcnt vmcnt(0)
    s_branch L_tagchk
L_tagok:
    v_lshlrev_b32 v8, 12, v1
    s_lshl_b32 s58, s40, 7
    s_add_u32 s58, s58, 49152
    v_add_u32 v8, s58, v8
    v_mov_b32 v2, s27
    s_mov_b64 exec, 3
    global_store_dword v8, v2, s[24:25] sc0 sc1
    s_mov_b64 exec, -1
L_noadd:
    s_waitcnt lgkmcnt(0)
    s_load_dword s85, s[18:19], 0
    v_and_b32 v1, 63, v0
    v_lshrrev_b32 v10, 3, v1
    s_mov_b32 s40, s86
    v_lshlrev_b32 v9, 4, v1
    s_lshl_b32 s61, s84, 2
    s_add_u32 s61, s61, s40
    s_mul_i32 s42, s61, 104
    v_add_u32 v12, 0, v10
    v_add_u32 v13, 8, v10
    v_add_u32 v14, 16, v10
    v_add_u32 v15, 24, v10
    v_cmp_gt_u32 vcc, 26, v15
    s_nop 1
    v_cndmask_b32 v15, 0, v15, vcc
    v_lshlrev_b32 v12, 2, v12
    v_lshlrev_b32 v13, 2, v13
    v_lshlrev_b32 v14, 2, v14
    v_lshlrev_b32 v15, 2, v15
    s_mov_b32 s28, s4
    s_mov_b32 s29, s5
    s_mov_b32 s30, 106496
    s_mov_b32 s31, 0x20000
    s_mov_b32 s36, s6
    s_mov_b32 s37, s7
    s_mov_b32 s38, 128000
    s_mov_b32 s39, 0x20000
    s_mov_b32 s32, s24
    s_mov_b32 s33, s25
    s_mov_b32 s34, 47104
    s_mov_b32 s35, 0x20000
    buffer_load_dword v12, v12, s[28:31], s42 offen
    buffer_load_dword v13, v13, s[28:31], s42 offen
    buffer_load_dword v14, v14, s[28:31], s42 offen
    buffer_load_dword v15, v15, s[28:31], s42 offen
    v_and_b32 v11, 7, v1
    v_lshlrev_b32 v11, 4, v11
    s_lshl_b32 s44, s40, 12
    s_add_u32 s44, s44, 98304
    s_add_u32 m0, s44, 0
    s_waitcnt vmcnt(3)
    v_lshl_add_u32 v12, v12, 7, v11
    buffer_load_dwordx4 v12, s[36:39], 0 offen lds
    s_add_u32 m0, s44, 1024
    s_waitcnt vmcnt(3)
    v_lshl_add_u32 v13, v13, 7, v11
    buffer_load_dwordx4 v13, s[36:39], 0 offen lds
    s_add_u32 m0, s44, 2048
    s_waitcnt vmcnt(3)
    v_lshl_add_u32 v14, v14, 7, v11
    buffer_load_dwordx4 v14, s[36:39], 0 offen lds
    s_add_u32 m0, s44, 3072
    s_waitcnt vmcnt(3)
    v_lshl_add_u32 v15, v15, 7, v11
    buffer_load_dwordx4 v15, s[36:39], 0 offen lds
    v_and_b32 v5, 31, v1
    v_lshlrev_b32 v5, 2, v5
    v_lshrrev_b32 v6, 5, v1
    v_lshl_add_u32 v5, v6, 7, v5
    v_add_u32 v5, s44, v5
    s_waitcnt vmcnt(0)
    ds_read_b32 v36, v5 offset:0
    ds_read_b32 v37, v5 offset:128
    ds_read_b32 v38, v5 offset:256
    ds_read_b32 v39, v5 offset:384
    ds_read_b32 v40, v5 offset:512
    ds_read_b32 v41, v5 offset:640
    ds_read_b32 v42, v5 offset:768
    ds_read_b32 v43, v5 offset:896
    ds_read_b32 v44, v5 offset:1024
    ds_read_b32 v45, v5 offset:1152
    ds_read_b32 v46, v5 offset:1280
    ds_read_b32 v47, v5 offset:1408
    ds_read_b32 v48, v5 offset:1536
    ds_read_b32 v49, v5 offset:1664
    ds_read_b32 v50, v5 offset:1792
    ds_read_b32 v51, v5 offset:1920
    ds_read_b32 v52, v5 offset:2048
    ds_read_b32 v53, v5 offset:2176
    ds_read_b32 v54, v5 offset:2304
    ds_read_b32 v55, v5 offset:2432
    ds_read_b32 v56, v5 offset:2560
    ds_read_b32 v57, v5 offset:2688
    ds_read_b32 v58, v5 offset:2816
    ds_read_b32 v59, v5 offset:2944
    ds_read_b32 v60, v5 offset:3072
    ds_read_b32 v61, v5 offset:3200
    s_waitcnt lgkmcnt(0)
    v_lshlrev_b32 v10, 16, v36
    v_and_b32 v36, 0xffff0000, v36
    v_lshlrev_b32 v11, 16, v37
    v_and_b32 v37, 0xffff0000, v37
    v_lshlrev_b32 v12, 16, v38
    v_and_b32 v38, 0xffff0000, v38
    v_lshlrev_b32 v13, 16, v39
    v_and_b32 v39, 0xffff0000, v39
    v_lshlrev_b32 v14, 16, v40
    v_and_b32 v40, 0xffff0000, v40
    v_lshlrev_b32 v15, 16, v41
    v_and_b32 v41, 0xffff0000, v41
    v_lshlrev_b32 v16, 16, v42
    v_and_b32 v42, 0xffff0000, v42
    v_lshlrev_b32 v17, 16, v43
    v_and_b32 v43, 0xffff0000, v43
    v_lshlrev_b32 v18, 16, v44
    v_and_b32 v44, 0xffff0000, v44
    v_lshlrev_b32 v19, 16, v45
    v_and_b32 v45, 0xffff0000, v45
    v_lshlrev_b32 v20, 16, v46
    v_and_b32 v46, 0xffff0000, v46
    v_lshlrev_b32 v21, 16, v47
    v_and_b32 v47, 0xffff0000, v47
    v_lshlrev_b32 v22, 16, v48
    v_and_b32 v48, 0xffff0000, v48
    v_lshlrev_b32 v23, 16, v49
    v_and_b32 v49, 0xffff0000, v49
    v_lshlrev_b32 v24, 16, v50
    v_and_b32 v50, 0xffff0000, v50
    v_lshlrev_b32 v25, 16, v51
    v_and_b32 v51, 0xffff0000, v51
    v_lshlrev_b32 v26, 16, v52
    v_and_b32 v52, 0xffff0000, v52
    v_lshlrev_b32 v27, 16, v53
    v_and_b32 v53, 0xffff0000, v53
    v_lshlrev_b32 v28, 16, v54
    v_and_b32 v54, 0xffff0000, v54
    v_lshlrev_b32 v29, 16, v55
    v_and_b32 v55, 0xffff0000, v55
    v_lshlrev_b32 v30, 16, v56
    v_and_b32 v56, 0xffff0000, v56
    v_lshlrev_b32 v31, 16, v57
    v_and_b32 v57, 0xffff0000, v57
    v_lshlrev_b32 v32, 16, v58
    v_and_b32 v58, 0xffff0000, v58
    v_lshlrev_b32 v33, 16, v59
    v_and_b32 v59, 0xffff0000, v59
    v_lshlrev_b32 v34, 16, v60
    v_and_b32 v60, 0xffff0000, v60
    v_lshlrev_b32 v35, 16, v61
    v_and_b32 v61, 0xffff0000, v61
    v_mul_f32 v62, v10, v10
    v_mul_f32 v63, v12, v12
    v_mul_f32 v64, v14, v14
    v_mul_f32 v65, v16, v16
    v_cvt_pk_bf16_f32 v128, v62, v63
    v_mul_f32 v66, v18, v18
    v_mul_f32 v67, v20, v20
    v_cvt_pk_bf16_f32 v129, v64, v65
    v_mul_f32 v62, v22, v22
    v_mul_f32 v63, v24, v24
    v_cvt_pk_bf16_f32 v130, v66, v67
    v_mul_f32 v64, v26, v26
    v_mul_f32 v65, v28, v28
    v_cvt_pk_bf16_f32 v131, v62, v63
    v_mul_f32 v66, v30, v30
    v_mul_f32 v67, v32, v32
    v_cvt_pk_bf16_f32 v132, v64, v65
    v_mul_f32 v62, v34, v34
    v_mul_f32 v63, v10, v11
    v_cvt_pk_bf16_f32 v133, v66, v67
    v_mul_f32 v64, v12, v13
    v_mul_f32 v65, v14, v15
    v_cvt_pk_bf16_f32 v134, v62, v63
    v_mul_f32 v66, v16, v17
    v_mul_f32 v67, v18, v19
    v_cvt_pk_bf16_f32 v135, v64, v65
    v_mul_f32 v62, v20, v21
    v_mul_f32 v63, v22, v23
    v_cvt_pk_bf16_f32 v136, v66, v67
    v_mul_f32 v64, v24, v25
    v_mul_f32 v65, v26, v27
    v_cvt_pk_bf16_f32 v137, v62, v63
    v_mul_f32 v66, v28, v29
    v_mul_f32 v67, v30, v31
    v_cvt_pk_bf16_f32 v138, v64, v65
    v_mul_f32 v62, v32, v33
    v_mul_f32 v63, v34, v35
    v_cvt_pk_bf16_f32 v139, v66, v67
    v_mul_f32 v64, v10, v12
    v_mul_f32 v65, v12, v14
    v_cvt_pk_bf16_f32 v140, v62, v63
    v_mul_f32 v66, v14, v16
    v_mul_f32 v67, v16, v18
    v_cvt_pk_bf16_f32 v141, v64, v65
    v_mul_f32 v62, v18, v20
    v_mul_f32 v63, v20, v22
    v_cvt_pk_bf16_f32 v142, v66, v67
    v_mul_f32 v64, v22, v24
    v_mul_f32 v65, v24, v26
    v_cvt_pk_bf16_f32 v143, v62, v63
    v_mul_f32 v66, v26, v28
    v_mul_f32 v67, v28, v30
    v_cvt_pk_bf16_f32 v144, v64, v65
    v_mul_f32 v62, v30, v32
    v_mul_f32 v63, v32, v34
    v_cvt_pk_bf16_f32 v145, v66, v67
    v_mul_f32 v64, v34, v10
    v_mul_f32 v65, v10, v13
    v_cvt_pk_bf16_f32 v146, v62, v63
    v_mul_f32 v66, v12, v15
    v_mul_f32 v67, v14, v17
    v_cvt_pk_bf16_f32 v147, v64, v65
    v_mul_f32 v62, v16, v19
    v_mul_f32 v63, v18, v21
    v_cvt_pk_bf16_f32 v148, v66, v67
    v_mul_f32 v64, v20, v23
    v_mul_f32 v65, v22, v25
    v_cvt_pk_bf16_f32 v149, v62, v63
    v_mul_f32 v66, v24, v27
    v_mul_f32 v67, v26, v29
    v_cvt_pk_bf16_f32 v150, v64, v65
    v_mul_f32 v62, v28, v31
    v_mul_f32 v63, v30, v33
    v_cvt_pk_bf16_f32 v151, v66, v67
    v_mul_f32 v64, v32, v35
    v_mul_f32 v65, v34, v11
    v_cvt_pk_bf16_f32 v152, v62, v63
    v_mul_f32 v66, v10, v14
    v_mul_f32 v67, v12, v16
    v_cvt_pk_bf16_f32 v153, v64, v65
    v_mul_f32 v62, v14, v18
    v_mul_f32 v63, v16, v20
    v_cvt_pk_bf16_f32 v154, v66, v67
    v_mul_f32 v64, v18, v22
    v_mul_f32 v65, v20, v24
    v_cvt_pk_bf16_f32 v155, v62, v63
    v_mul_f32 v66, v22, v26
    v_mul_f32 v67, v24, v28
    v_cvt_pk_bf16_f32 v156, v64, v65
    v_mul_f32 v62, v26, v30
    v_mul_f32 v63, v28, v32
    v_cvt_pk_bf16_f32 v157, v66, v67
    v_mul_f32 v64, v30, v34
    v_mul_f32 v65, v32, v10
    v_cvt_pk_bf16_f32 v158, v62, v63
    v_mul_f32 v66, v34, v12
    v_mul_f32 v67, v10, v15
    v_cvt_pk_bf16_f32 v159, v64, v65
    v_mul_f32 v62, v12, v17
    v_mul_f32 v63, v14, v19
    v_cvt_pk_bf16_f32 v160, v66, v67
    v_mul_f32 v64, v16, v21
    v_mul_f32 v65, v18, v23
    v_cvt_pk_bf16_f32 v161, v62, v63
    v_mul_f32 v66, v20, v25
    v_mul_f32 v67, v22, v27
    v_cvt_pk_bf16_f32 v162, v64, v65
    v_mul_f32 v62, v24, v29
    v_mul_f32 v63, v26, v31
    v_cvt_pk_bf16_f32 v163, v66, v67
    v_mul_f32 v64, v28, v33
    v_mul_f32 v65, v30, v35
    v_cvt_pk_bf16_f32 v164, v62, v63
    v_mul_f32 v66, v32, v11
    v_mul_f32 v67, v34, v13
    v_cvt_pk_bf16_f32 v165, v64, v65
    v_mul_f32 v62, v10, v16
    v_mul_f32 v63, v12, v18
    v_cvt_pk_bf16_f32 v166, v66, v67
    v_mul_f32 v64, v14, v20
    v_mul_f32 v65, v16, v22
    v_cvt_pk_bf16_f32 v167, v62, v63
    v_mul_f32 v66, v18, v24
    v_mul_f32 v67, v20, v26
    v_cvt_pk_bf16_f32 v168, v64, v65
    v_mul_f32 v62, v22, v28
    v_mul_f32 v63, v24, v30
    v_cvt_pk_bf16_f32 v169, v66, v67
    v_mul_f32 v64, v26, v32
    v_mul_f32 v65, v28, v34
    v_cvt_pk_bf16_f32 v170, v62, v63
    v_mul_f32 v66, v30, v10
    v_mul_f32 v67, v32, v12
    v_cvt_pk_bf16_f32 v171, v64, v65
    v_mul_f32 v62, v34, v14
    v_mul_f32 v63, v10, v17
    v_cvt_pk_bf16_f32 v172, v66, v67
    v_mul_f32 v64, v12, v19
    v_mul_f32 v65, v14, v21
    v_cvt_pk_bf16_f32 v173, v62, v63
    v_mul_f32 v66, v16, v23
    v_mul_f32 v67, v18, v25
    v_cvt_pk_bf16_f32 v174, v64, v65
    v_mul_f32 v62, v20, v27
    v_mul_f32 v63, v22, v29
    v_cvt_pk_bf16_f32 v175, v66, v67
    v_mul_f32 v64, v24, v31
    v_mul_f32 v65, v26, v33
    v_cvt_pk_bf16_f32 v176, v62, v63
    v_mul_f32 v66, v28, v35
    v_mul_f32 v67, v30, v11
    v_cvt_pk_bf16_f32 v177, v64, v65
    v_mul_f32 v62, v32, v13
    v_mul_f32 v63, v34, v15
    v_cvt_pk_bf16_f32 v178, v66, v67
    v_mul_f32 v64, v10, v18
    v_mul_f32 v65, v12, v20
    v_cvt_pk_bf16_f32 v179, v62, v63
    v_mul_f32 v66, v14, v22
    v_mul_f32 v67, v16, v24
    v_cvt_pk_bf16_f32 v180, v64, v65
    v_mul_f32 v62, v18, v26
    v_mul_f32 v63, v20, v28
    v_cvt_pk_bf16_f32 v181, v66, v67
    v_mul_f32 v64, v22, v30
    v_mul_f32 v65, v24, v32
    v_cvt_pk_bf16_f32 v182, v62, v63
    v_mul_f32 v66, v26, v34
    v_mul_f32 v67, v28, v10
    v_cvt_pk_bf16_f32 v183, v64, v65
    v_mul_f32 v62, v30, v12
    v_mul_f32 v63, v32, v14
    v_cvt_pk_bf16_f32 v184, v66, v67
    v_mul_f32 v64, v34, v16
    v_mul_f32 v65, v10, v19
    v_cvt_pk_bf16_f32 v185, v62, v63
    v_mul_f32 v66, v12, v21
    v_mul_f32 v67, v14, v23
    v_cvt_pk_bf16_f32 v186, v64, v65
    v_mul_f32 v62, v16, v25
    v_mul_f32 v63, v18, v27
    v_cvt_pk_bf16_f32 v187, v66, v67
    v_mul_f32 v64, v20, v29
    v_mul_f32 v65, v22, v31
    v_cvt_pk_bf16_f32 v188, v62, v63
    v_mul_f32 v66, v24, v33
    v_mul_f32 v67, v26, v35
    v_cvt_pk_bf16_f32 v189, v64, v65
    v_mul_f32 v62, v28, v11
    v_mul_f32 v63, v30, v13
    v_cvt_pk_bf16_f32 v190, v66, v67
    v_mul_f32 v64, v32, v15
    v_mul_f32 v65, v34, v17
    v_cvt_pk_bf16_f32 v191, v62, v63
    v_mul_f32 v66, v10, v20
    v_mul_f32 v67, v12, v22
    v_cvt_pk_bf16_f32 v192, v64, v65
    v_mul_f32 v62, v14, v24
    v_mul_f32 v63, v16, v26
    v_cvt_pk_bf16_f32 v193, v66, v67
    v_mul_f32 v64, v18, v28
    v_mul_f32 v65, v20, v30
    v_cvt_pk_bf16_f32 v194, v62, v63
    v_mul_f32 v66, v22, v32
    v_mul_f32 v67, v24, v34
    v_cvt_pk_bf16_f32 v195, v64, v65
    v_mul_f32 v62, v26, v10
    v_mul_f32 v63, v28, v12
    v_cvt_pk_bf16_f32 v196, v66, v67
    v_mul_f32 v64, v30, v14
    v_mul_f32 v65, v32, v16
    v_cvt_pk_bf16_f32 v197, v62, v63
    v_mul_f32 v66, v34, v18
    v_mul_f32 v67, v10, v21
    v_cvt_pk_bf16_f32 v198, v64, v65
    v_mul_f32 v62, v12, v23
    v_mul_f32 v63, v14, v25
    v_cvt_pk_bf16_f32 v199, v66, v67
    v_mul_f32 v64, v16, v27
    v_mul_f32 v65, v18, v29
    v_cvt_pk_bf16_f32 v200, v62, v63
    v_mul_f32 v66, v20, v31
    v_mul_f32 v67, v22, v33
    v_cvt_pk_bf16_f32 v201, v64, v65
    v_mul_f32 v62, v24, v35
    v_mul_f32 v63, v26, v11
    v_cvt_pk_bf16_f32 v202, v66, v67
    v_mul_f32 v64, v28, v13
    v_mul_f32 v65, v30, v15
    v_cvt_pk_bf16_f32 v203, v62, v63
    v_mul_f32 v66, v32, v17
    v_mul_f32 v67, v34, v19
    v_cvt_pk_bf16_f32 v204, v64, v65
    v_mul_f32 v62, v10, v22
    v_mul_f32 v63, v12, v24
    v_cvt_pk_bf16_f32 v205, v66, v67
    v_mul_f32 v64, v14, v26
    v_mul_f32 v65, v16, v28
    v_cvt_pk_bf16_f32 v206, v62, v63
    v_mul_f32 v66, v18, v30
    v_mul_f32 v67, v20, v32
    v_cvt_pk_bf16_f32 v207, v64, v65
    v_mul_f32 v62, v22, v34
    v_mul_f32 v63, v24, v10
    v_cvt_pk_bf16_f32 v208, v66, v67
    v_mul_f32 v64, v26, v12
    v_mul_f32 v65, v28, v14
    v_cvt_pk_bf16_f32 v209, v62, v63
    v_mul_f32 v66, v30, v16
    v_mul_f32 v67, v32, v18
    v_cvt_pk_bf16_f32 v210, v64, v65
    v_mul_f32 v62, v34, v20
    v_mul_f32 v63, v10, v23
    v_cvt_pk_bf16_f32 v211, v66, v67
    v_mul_f32 v64, v12, v25
    v_mul_f32 v65, v14, v27
    v_cvt_pk_bf16_f32 v212, v62, v63
    v_mul_f32 v66, v16, v29
    v_mul_f32 v67, v18, v31
    v_cvt_pk_bf16_f32 v213, v64, v65
    v_mul_f32 v62, v20, v33
    v_mul_f32 v63, v22, v35
    v_cvt_pk_bf16_f32 v214, v66, v67
    v_cvt_pk_bf16_f32 v215, v62, v63
    v_cvt_pk_bf16_f32 v216, v10, v12
    v_cvt_pk_bf16_f32 v217, v14, v16
    v_cvt_pk_bf16_f32 v218, v18, v20
    v_cvt_pk_bf16_f32 v219, v22, v24
    v_cvt_pk_bf16_f32 v220, v26, v28
    v_cvt_pk_bf16_f32 v221, v30, v32
    v_cvt_pk_bf16_f32 v222, v34, 1.0
    v_mul_f32 v64, v36, v36
    v_mul_f32 v65, v38, v38
    v_cvt_pk_bf16_f32 v223, 0, 0
    v_mul_f32 v66, v40, v40
    v_mul_f32 v67, v42, v42
    v_cvt_pk_bf16_f32 v224, v64, v65
    v_mul_f32 v62, v44, v44
    v_mul_f32 v63, v46, v46
    v_cvt_pk_bf16_f32 v225, v66, v67
    v_mul_f32 v64, v48, v48
    v_mul_f32 v65, v50, v50
    v_cvt_pk_bf16_f32 v226, v62, v63
    v_mul_f32 v66, v52, v52
    v_mul_f32 v67, v54, v54
    v_cvt_pk_bf16_f32 v227, v64, v65
    v_mul_f32 v62, v56, v56
    v_mul_f32 v63, v58, v58
    v_cvt_pk_bf16_f32 v228, v66, v67
    v_mul_f32 v64, v60, v60
    v_mul_f32 v65, v36, v37
    v_cvt_pk_bf16_f32 v229, v62, v63
    v_mul_f32 v66, v38, v39
    v_mul_f32 v67, v40, v41
    v_cvt_pk_bf16_f32 v230, v64, v65
    v_mul_f32 v62, v42, v43
    v_mul_f32 v63, v44, v45
    v_cvt_pk_bf16_f32 v231, v66, v67
    v_mul_f32 v64, v46, v47
    v_mul_f32 v65, v48, v49
    v_cvt_pk_bf16_f32 v232, v62, v63
    v_mul_f32 v66, v50, v51
    v_mul_f32 v67, v52, v53
    v_cvt_pk_bf16_f32 v233, v64, v65
    v_mul_f32 v62, v54, v55
    v_mul_f32 v63, v56, v57
    v_cvt_pk_bf16_f32 v234, v66, v67
    v_mul_f32 v64, v58, v59
    v_mul_f32 v65, v60, v61
    v_cvt_pk_bf16_f32 v235, v62, v63
    v_mul_f32 v66, v36, v38
    v_mul_f32 v67, v38, v40
    v_cvt_pk_bf16_f32 v236, v64, v65
    v_mul_f32 v62, v40, v42
    v_mul_f32 v63, v42, v44
    v_cvt_pk_bf16_f32 v237, v66, v67
    v_mul_f32 v64, v44, v46
    v_mul_f32 v65, v46, v48
    v_cvt_pk_bf16_f32 v238, v62, v63
    v_mul_f32 v66, v48, v50
    v_mul_f32 v67, v50, v52
    v_cvt_pk_bf16_f32 v239, v64, v65
    v_mul_f32 v62, v52, v54
    v_mul_f32 v63, v54, v56
    v_cvt_pk_bf16_f32 v240, v66, v67
    v_mul_f32 v64, v56, v58
    v_mul_f32 v65, v58, v60
    v_cvt_pk_bf16_f32 v241, v62, v63
    v_mul_f32 v66, v60, v36
    v_mul_f32 v67, v36, v39
    v_cvt_pk_bf16_f32 v242, v64, v65
    v_mul_f32 v62, v38, v41
    v_mul_f32 v63, v40, v43
    v_cvt_pk_bf16_f32 v243, v66, v67
    v_mul_f32 v64, v42, v45
    v_mul_f32 v65, v44, v47
    v_cvt_pk_bf16_f32 v244, v62, v63
    v_mul_f32 v66, v46, v49
    v_mul_f32 v67, v48, v51
    v_cvt_pk_bf16_f32 v245, v64, v65
    v_mul_f32 v62, v50, v53
    v_mul_f32 v63, v52, v55
    v_cvt_pk_bf16_f32 v246, v66, v67
    v_mul_f32 v64, v54, v57
    v_mul_f32 v65, v56, v59
    v_cvt_pk_bf16_f32 v247, v62, v63
    v_mul_f32 v66, v58, v61
    v_mul_f32 v67, v60, v37
    v_cvt_pk_bf16_f32 v248, v64, v65
    v_mul_f32 v62, v36, v40
    v_mul_f32 v63, v38, v42
    v_cvt_pk_bf16_f32 v249, v66, v67
    v_mul_f32 v64, v40, v44
    v_mul_f32 v65, v42, v46
    v_cvt_pk_bf16_f32 v250, v62, v63
    v_mul_f32 v66, v44, v48
    v_mul_f32 v67, v46, v50
    v_cvt_pk_bf16_f32 v251, v64, v65
    v_mul_f32 v62, v48, v52
    v_mul_f32 v63, v50, v54
    v_cvt_pk_bf16_f32 v252, v66, v67
    v_mul_f32 v64, v52, v56
    v_mul_f32 v65, v54, v58
    v_cvt_pk_bf16_f32 v253, v62, v63
    v_mul_f32 v66, v56, v60
    v_mul_f32 v67, v58, v36
    v_cvt_pk_bf16_f32 v254, v64, v65
    v_mul_f32 v62, v60, v38
    v_mul_f32 v63, v36, v41
    v_cvt_pk_bf16_f32 v255, v66, v67
    v_mul_f32 v64, v38, v43
    v_mul_f32 v65, v40, v45
    v_cvt_pk_bf16_f32 v72, v62, v63
    v_mul_f32 v66, v42, v47
    v_mul_f32 v67, v44, v49
    v_cvt_pk_bf16_f32 v73, v64, v65
    v_mul_f32 v62, v46, v51
    v_mul_f32 v63, v48, v53
    v_cvt_pk_bf16_f32 v74, v66, v67
    v_mul_f32 v64, v50, v55
    v_mul_f32 v65, v52, v57
    v_cvt_pk_bf16_f32 v75, v62, v63
    v_mul_f32 v66, v54, v59
    v_mul_f32 v67, v56, v61
    v_cvt_pk_bf16_f32 v76, v64, v65
    v_mul_f32 v62, v58, v37
    v_mul_f32 v63, v60, v39
    v_cvt_pk_bf16_f32 v77, v66, v67
    v_mul_f32 v64, v36, v42
    v_mul_f32 v65, v38, v44
    v_cvt_pk_bf16_f32 v78, v62, v63
    v_mul_f32 v66, v40, v46
    v_mul_f32 v67, v42, v48
    v_cvt_pk_bf16_f32 v79, v64, v65
    v_mul_f32 v62, v44, v50
    v_mul_f32 v63, v46, v52
    v_cvt_pk_bf16_f32 v80, v66, v67
    v_mul_f32 v64, v48, v54
    v_mul_f32 v65, v50, v56
    v_cvt_pk_bf16_f32 v81, v62, v63
    v_mul_f32 v66, v52, v58
    v_mul_f32 v67, v54, v60
    v_cvt_pk_bf16_f32 v82, v64, v65
    v_mul_f32 v62, v56, v36
    v_mul_f32 v63, v58, v38
    v_cvt_pk_bf16_f32 v83, v66, v67
    v_mul_f32 v64, v60, v40
    v_mul_f32 v65, v36, v43
    v_cvt_pk_bf16_f32 v84, v62, v63
    v_mul_f32 v66, v38, v45
    v_mul_f32 v67, v40, v47
    v_cvt_pk_bf16_f32 v85, v64, v65
    v_mul_f32 v62, v42, v49
    v_mul_f32 v63, v44, v51
    v_cvt_pk_bf16_f32 v86, v66, v67
    v_mul_f32 v64, v46, v53
    v_mul_f32 v65, v48, v55
    v_cvt_pk_bf16_f32 v87, v62, v63
    v_mul_f32 v66, v50, v57
    v_mul_f32 v67, v52, v59
    v_cvt_pk_bf16_f32 v88, v64, v65
    v_mul_f32 v62, v54, v61
    v_mul_f32 v63, v56, v37
    v_cvt_pk_bf16_f32 v89, v66, v67
    v_mul_f32 v64, v58, v39
    v_mul_f32 v65, v60, v41
    v_cvt_pk_bf16_f32 v90, v62, v63
    v_mul_f32 v66, v36, v44
    v_mul_f32 v67, v38, v46
    v_cvt_pk_bf16_f32 v91, v64, v65
    v_mul_f32 v62, v40, v48
    v_mul_f32 v63, v42, v50
    v_cvt_pk_bf16_f32 v92, v66, v67
    v_mul_f32 v64, v44, v52
    v_mul_f32 v65, v46, v54
    v_cvt_pk_bf16_f32 v93, v62, v63
    v_mul_f32 v66, v48, v56
    v_mul_f32 v67, v50, v58
    v_cvt_pk_bf16_f32 v94, v64, v65
    v_mul_f32 v62, v52, v60
    v_mul_f32 v63, v54, v36
    v_cvt_pk_bf16_f32 v95, v66, v67
    v_mul_f32 v64, v56, v38
    v_mul_f32 v65, v58, v40
    v_cvt_pk_bf16_f32 v96, v62, v63
    v_mul_f32 v66, v60, v42
    v_mul_f32 v67, v36, v45
    v_cvt_pk_bf16_f32 v97, v64, v65
    v_mul_f32 v62, v38, v47
    v_mul_f32 v63, v40, v49
    v_cvt_pk_bf16_f32 v98, v66, v67
    v_mul_f32 v64, v42, v51
    v_mul_f32 v65, v44, v53
    v_cvt_pk_bf16_f32 v99, v62, v63
    v_mul_f32 v66, v46, v55
    v_mul_f32 v67, v48, v57
    v_cvt_pk_bf16_f32 v100, v64, v65
    v_mul_f32 v62, v50, v59
    v_mul_f32 v63, v52, v61
    v_cvt_pk_bf16_f32 v101, v66, v67
    v_mul_f32 v64, v54, v37
    v_mul_f32 v65, v56, v39
    v_cvt_pk_bf16_f32 v102, v62, v63
    v_mul_f32 v66, v58, v41
    v_mul_f32 v67, v60, v43
    v_cvt_pk_bf16_f32 v103, v64, v65
    v_mul_f32 v62, v36, v46
    v_mul_f32 v63, v38, v48
    v_cvt_pk_bf16_f32 v104, v66, v67
    v_mul_f32 v64, v40, v50
    v_mul_f32 v65, v42, v52
    v_cvt_pk_bf16_f32 v105, v62, v63
    v_mul_f32 v66, v44, v54
    v_mul_f32 v67, v46, v56
    v_cvt_pk_bf16_f32 v106, v64, v65
    v_mul_f32 v62, v48, v58
    v_mul_f32 v63, v50, v60
    v_cvt_pk_bf16_f32 v107, v66, v67
    v_mul_f32 v64, v52, v36
    v_mul_f32 v65, v54, v38
    v_cvt_pk_bf16_f32 v108, v62, v63
    v_mul_f32 v66, v56, v40
    v_mul_f32 v67, v58, v42
    v_cvt_pk_bf16_f32 v109, v64, v65
    v_mul_f32 v62, v60, v44
    v_mul_f32 v63, v36, v47
    v_cvt_pk_bf16_f32 v110, v66, v67
    v_mul_f32 v64, v38, v49
    v_mul_f32 v65, v40, v51
    v_cvt_pk_bf16_f32 v111, v62, v63
    v_mul_f32 v66, v42, v53
    v_mul_f32 v67, v44, v55
    v_cvt_pk_bf16_f32 v112, v64, v65
    v_mul_f32 v62, v46, v57
    v_mul_f32 v63, v48, v59
    v_cvt_pk_bf16_f32 v113, v66, v67
    v_mul_f32 v64, v50, v61
    v_mul_f32 v65, v52, v37
    v_cvt_pk_bf16_f32 v114, v62, v63
    v_mul_f32 v66, v54, v39
    v_mul_f32 v67, v56, v41
    v_cvt_pk_bf16_f32 v115, v64, v65
    v_mul_f32 v62, v58, v43
    v_mul_f32 v63, v60, v45
    v_cvt_pk_bf16_f32 v116, v66, v67
    v_mul_f32 v64, v36, v48
    v_mul_f32 v65, v38, v50
    v_cvt_pk_bf16_f32 v117, v62, v63
    v_mul_f32 v66, v40, v52
    v_mul_f32 v67, v42, v54
    v_cvt_pk_bf16_f32 v118, v64, v65
    v_mul_f32 v62, v44, v56
    v_mul_f32 v63, v46, v58
    v_cvt_pk_bf16_f32 v119, v66, v67
    v_mul_f32 v64, v48, v60
    v_mul_f32 v65, v50, v36
    v_cvt_pk_bf16_f32 v120, v62, v63
    v_mul_f32 v66, v52, v38
    v_mul_f32 v67, v54, v40
    v_cvt_pk_bf16_f32 v121, v64, v65
    v_mul_f32 v62, v56, v42
    v_mul_f32 v63, v58, v44
    v_cvt_pk_bf16_f32 v122, v66, v67
    v_mul_f32 v64, v60, v46
    v_mul_f32 v65, v36, v49
    v_cvt_pk_bf16_f32 v123, v62, v63
    v_mul_f32 v66, v38, v51
    v_mul_f32 v67, v40, v53
    v_cvt_pk_bf16_f32 v124, v64, v65
    v_mul_f32 v62, v42, v55
    v_mul_f32 v63, v44, v57
    v_cvt_pk_bf16_f32 v125, v66, v67
    v_mul_f32 v64, v46, v59
    v_mul_f32 v65, v48, v61
    v_cvt_pk_bf16_f32 v126, v62, v63
    v_cvt_pk_bf16_f32 v127, v64, v65
    v_cvt_pk_bf16_f32 v10, v36, v38
    v_cvt_pk_bf16_f32 v11, v40, v42
    v_cvt_pk_bf16_f32 v12, v44, v46
    v_cvt_pk_bf16_f32 v13, v48, v50
    v_cvt_pk_bf16_f32 v14, v52, v54
    v_cvt_pk_bf16_f32 v15, v56, v58
    v_cvt_pk_bf16_f32 v16, v60, 1.0
    v_cvt_pk_bf16_f32 v17, 0, 0
    v_min_u32 v8, 12, v1
    v_lshlrev_b32 v8, 7, v8
    v_add_u32 v8, 53248, v8
    v_mov_b32 v5, 0
L_hpoll:
    global_load_dwordx2 v[2:3], v5, s[22:23] sc1
    global_load_dword v4, v8, s[24:25] sc1
    s_waitcnt vmcnt(0)
    v_cmp_ne_u32 vcc, v3, v4
    v_cmp_eq_u32 s[58:59], 0, v2
    v_readfirstlane_b32 s27, v3
    s_or_b64 vcc, vcc, s[58:59]
    s_cbranch_scc0 L_hgo
    s_sub_u32 s92, s92, 1
    s_cbranch_scc1 L_exit
    s_sleep 10
    s_branch L_hpoll
L_hgo:
    s_lshl_b32 s58, s40, 11
    s_add_u32 s26, s58, 131072
    s_add_u32 m0, s26, 16384
    s_lshl_b32 s58, s40, 11
    buffer_load_dwordx4 v9, s[32:35], s58 offen offset:0 sc1 lds
    buffer_load_dwordx4 v9, s[32:35], s58 offen offset:1024 sc1 lds
    s_add_u32 m0, s26, 24576
    s_lshl_b32 s58, s40, 11
    s_add_u32 s58, s58, 8192
    buffer_load_dwordx4 v9, s[32:35], s58 offen offset:0 sc1 lds
    buffer_load_dwordx4 v9, s[32:35], s58 offen offset:1024 sc1 lds
    s_lshl_b32 s58, s40, 13
    s_add_u32 m0, s58, 65536
    s_add_u32 s58, s58, 16384
    buffer_load_dwordx4 v9, s[32:35], s58 offen offset:0 sc1 lds
    buffer_load_dwordx4 v9, s[32:35], s58 offen offset:1024 sc1 lds
    buffer_load_dwordx4 v9, s[32:35], s58 offen offset:2048 sc1 lds
    buffer_load_dwordx4 v9, s[32:35], s58 offen offset:3072 sc1 lds
    s_lshl_b32 s58, s40, 13
    s_add_u32 m0, s58, 69632
    s_add_u32 s58, s58, 20480
    buffer_load_dwordx4 v9, s[32:35], s58 offen offset:0 sc1 lds
    buffer_load_dwordx4 v9, s[32:35], s58 offen offset:1024 sc1 lds
    buffer_load_dwordx4 v9, s[32:35], s58 offen offset:2048 sc1 lds
    buffer_load_dwordx4 v9, s[32:35], s58 offen offset:3072 sc1 lds
    s_mov_b32 s63, s85
    s_add_u32 s28, s24, 65536
    s_addc_u32 s29, s25, 0
    s_mov_b32 s30, 212992
    s_mov_b32 s31, 0x20000
    v_add_u32 v6, 131072, v9
    v_add_u32 v7, 65536, v9
    s_lshl_b32 s62, s61, 3
    v_lshlrev_b32 v4, 13, v1
    v_mov_b32 v5, 2147483647
    v_cmp_gt_u32 vcc, 26, v1
    s_nop 1
    v_cndmask_b32 v4, v5, v4, vcc
    s_mov_b32 s88, s20
    s_mov_b32 s89, s21
    s_mov_b32 s90, 2048
    s_mov_b32 s91, 0x20000
    s_lshl_b32 s63, s63, 16
    s_lshl_b32 s61, s61, 1
    s_waitcnt vmcnt(0)
    s_barrier
    ds_read_b128 v[52:55], v6 offset:16384
    ds_read_b128 v[56:59], v6 offset:17408
    ds_read_b128 v[60:63], v6 offset:18432
    ds_read_b128 v[64:67], v6 offset:19456
    ds_read_b128 v[68:71], v6 offset:20480
    s_waitcnt lgkmcnt(4)
    v_mfma_f32_32x32x16_bf16 v[18:33], v[52:55], v[224:227], 0
    ds_read_b128 v[52:55], v6 offset:21504
    s_waitcnt lgkmcnt(4)
    v_mfma_f32_32x32x16_bf16 v[34:49], v[56:59], v[224:227], 0
    ds_read_b128 v[56:59], v6 offset:22528
    ds_read_b128 v[224:227], v6 offset:23552
    s_waitcnt lgkmcnt(5)
    v_mfma_f32_32x32x16_bf16 v[18:33], v[60:63], v[228:231], v[18:33]
    ds_read_b128 v[60:63], v6 offset:24576
    s_waitcnt lgkmcnt(5)
    v_mfma_f32_32x32x16_bf16 v[34:49], v[64:67], v[228:231], v[34:49]
    ds_read_b128 v[64:67], v6 offset:25600
    ds_read_b128 v[228:231], v6 offset:26624
    s_waitcnt lgkmcnt(6)
    v_mfma_f32_32x32x16_bf16 v[18:33], v[68:71], v[232:235], v[18:33]
    ds_read_b128 v[68:71], v6 offset:27648
    s_waitcnt lgkmcnt(6)
    v_mfma_f32_32x32x16_bf16 v[34:49], v[52:55], v[232:235], v[34:49]
    ds_read_b128 v[52:55], v6 offset:28672
    s_waitcnt lgkmcnt(6)
    v_mfma_f32_32x32x16_bf16 v[18:33], v[56:59], v[236:239], v[18:33]
    ds_read_b128 v[232:235], v6 offset:29696
    s_waitcnt lgkmcnt(6)
    v_mfma_f32_32x32x16_bf16 v[34:49], v[224:227], v[236:239], v[34:49]
    ds_read_b128 v[56:59], v6 offset:30720
    s_waitcnt lgkmcnt(6)
    v_mfma_f32_32x32x16_bf16 v[18:33], v[60:63], v[240:243], v[18:33]
    ds_read_b128 v[224:227], v6 offset:31744
    s_waitcnt lgkmcnt(6)
    v_mfma_f32_32x32x16_bf16 v[34:49], v[64:67], v[240:243], v[34:49]
    ds_read_b128 v[60:63], v6 offset:16384
    s_waitcnt lgkmcnt(6)
    v_mfma_f32_32x32x16_bf16 v[18:33], v[228:231], v[244:247], v[18:33]
    ds_read_b128 v[64:67], v6 offset:17408
    s_waitcnt lgkmcnt(6)
    v_mfma_f32_32x32x16_bf16 v[34:49], v[68:71], v[244:247], v[34:49]
    ds_read_b128 v[68:71], v6 offset:18432
    s_waitcnt lgkmcnt(6)
    v_mfma_f32_32x32x16_bf16 v[18:33], v[52:55], v[248:251], v[18:33]
    ds_read_b128 v[52:55], v6 offset:19456
    s_waitcnt lgkmcnt(6)
    v_mfma_f32_32x32x16_bf16 v[34:49], v[232:235], v[248:251], v[34:49]
    s_waitcnt lgkmcnt(5)
    v_mfma_f32_32x32x16_bf16 v[18:33], v[56:59], v[252:255], v[18:33]
    ds_read_b128 v[56:59], v6 offset:20480
    s_waitcnt lgkmcnt(5)
    v_mfma_f32_32x32x16_bf16 v[34:49], v[224:227], v[252:255], v[34:49]
    s_waitcnt lgkmcnt(4)
    v_mfma_f32_32x32x16_bf16 v[224:239], v[60:63], v[128:131], 0
    ds_read_b128 v[60:63], v6 offset:21504
    s_waitcnt lgkmcnt(4)
    v_mfma_f32_32x32x16_bf16 v[240:255], v[64:67], v[128:131], 0
    ds_read_b128 v[64:67], v6 offset:22528
    ds_read_b128 v[128:131], v6 offset:23552
    s_waitcnt lgkmcnt(5)
    v_mfma_f32_32x32x16_bf16 v[224:239], v[68:71], v[132:135], v[224:239]
    ds_read_b128 v[68:71], v6 offset:24576
    s_waitcnt lgkmcnt(5)
    v_mfma_f32_32x32x16_bf16 v[240:255], v[52:55], v[132:135], v[240:255]
    ds_read_b128 v[52:55], v6 offset:25600
    ds_read_b128 v[132:135], v6 offset:26624
    s_waitcnt lgkmcnt(6)
    v_mfma_f32_32x32x16_bf16 v[224:239], v[56:59], v[136:139], v[224:239]
    ds_read_b128 v[56:59], v6 offset:27648
    s_waitcnt lgkmcnt(6)
    v_mfma_f32_32x32x16_bf16 v[240:255], v[60:63], v[136:139], v[240:255]
    ds_read_b128 v[60:63], v6 offset:28672
    s_waitcnt lgkmcnt(6)
    v_mfma_f32_32x32x16_bf16 v[224:239], v[64:67], v[140:143], v[224:239]
    ds_read_b128 v[136:139], v6 offset:29696
    s_waitcnt lgkmcnt(6)
    v_mfma_f32_32x32x16_bf16 v[240:255], v[128:131], v[140:143], v[240:255]
    ds_read_b128 v[64:67], v6 offset:30720
    s_waitcnt lgkmcnt(6)
    v_mfma_f32_32x32x16_bf16 v[224:239], v[68:71], v[144:147], v[224:239]
    ds_read_b128 v[128:131], v6 offset:31744
    ds_read_b128 v[140:143], v7 offset:0
    s_waitcnt lgkmcnt(7)
    v_mfma_f32_32x32x16_bf16 v[240:255], v[52:55], v[144:147], v[240:255]
    ds_read_b128 v[68:71], v7 offset:1024
    ds_read_b128 v[52:55], v7 offset:2048
    s_waitcnt lgkmcnt(8)
    v_mfma_f32_32x32x16_bf16 v[224:239], v[132:135], v[148:151], v[224:239]
    ds_read_b128 v[144:147], v7 offset:3072
    ds_read_b128 v[132:135], v7 offset:4096
    s_waitcnt lgkmcnt(9)
    v_mfma_f32_32x32x16_bf16 v[240:255], v[56:59], v[148:151], v[240:255]
    s_waitcnt lgkmcnt(8)
    v_mfma_f32_32x32x16_bf16 v[224:239], v[60:63], v[152:155], v[224:239]
    ds_read_b128 v[56:59], v7 offset:5120
    s_waitcnt lgkmcnt(8)
    v_mfma_f32_32x32x16_bf16 v[240:255], v[136:139], v[152:155], v[240:255]
    s_waitcnt lgkmcnt(7)
    v_mfma_f32_32x32x16_bf16 v[224:239], v[64:67], v[156:159], v[224:239]
    ds_read_b128 v[148:151], v7 offset:6144
    s_waitcnt lgkmcnt(7)
    v_mfma_f32_32x32x16_bf16 v[240:255], v[128:131], v[156:159], v[240:255]
    s_waitcnt lgkmcnt(6)
    v_mfma_f32_32x32x16_bf16 v[18:33], v[140:143], v[72:75], v[18:33]
    ds_read_b128 v[60:63], v7 offset:7168
    v_mfma_f32_32x32x16_bf16 v[224:239], v[140:143], v[160:163], v[224:239]
    s_waitcnt lgkmcnt(6)
    v_mfma_f32_32x32x16_bf16 v[34:49], v[68:71], v[72:75], v[34:49]
    ds_read_b128 v[136:139], v7 offset:8192
    v_mfma_f32_32x32x16_bf16 v[240:255], v[68:71], v[160:163], v[240:255]
    s_waitcnt lgkmcnt(6)
    v_mfma_f32_32x32x16_bf16 v[18:33], v[52:55], v[76:79], v[18:33]
    ds_read_b128 v[152:155], v7 offset:9216
    v_mfma_f32_32x32x16_bf16 v[224:239], v[52:55], v[164:167], v[224:239]
    s_waitcnt lgkmcnt(6)
    v_mfma_f32_32x32x16_bf16 v[34:49], v[144:147], v[76:79], v[34:49]
    ds_read_b128 v[64:67], v7 offset:10240
    v_mfma_f32_32x32x16_bf16 v[240:255], v[144:147], v[164:167], v[240:255]
    s_waitcnt lgkmcnt(6)
    v_mfma_f32_32x32x16_bf16 v[18:33], v[132:135], v[80:83], v[18:33]
    ds_read_b128 v[128:131], v7 offset:11264
    v_mfma_f32_32x32x16_bf16 v[224:239], v[132:135], v[168:171], v[224:239]
    s_waitcnt lgkmcnt(6)
    v_mfma_f32_32x32x16_bf16 v[34:49], v[56:59], v[80:83], v[34:49]
    ds_read_b128 v[156:159], v7 offset:12288
    v_mfma_f32_32x32x16_bf16 v[240:255], v[56:59], v[168:171], v[240:255]
    s_waitcnt lgkmcnt(6)
    v_mfma_f32_32x32x16_bf16 v[18:33], v[148:151], v[84:87], v[18:33]
    ds_read_b128 v[140:143], v7 offset:13312
    v_mfma_f32_32x32x16_bf16 v[224:239], v[148:151], v[172:175], v[224:239]
    s_waitcnt lgkmcnt(6)
    v_mfma_f32_32x32x16_bf16 v[34:49], v[60:63], v[84:87], v[34:49]
    ds_read_b128 v[68:71], v7 offset:14336
    v_mfma_f32_32x32x16_bf16 v[240:255], v[60:63], v[172:175], v[240:255]
    s_waitcnt lgkmcnt(6)
    v_mfma_f32_32x32x16_bf16 v[18:33], v[136:139], v[88:91], v[18:33]
    ds_read_b128 v[52:55], v7 offset:15360
    v_mfma_f32_32x32x16_bf16 v[224:239], v[136:139], v[176:179], v[224:239]
    s_waitcnt lgkmcnt(6)
    v_mfma_f32_32x32x16_bf16 v[34:49], v[152:155], v[88:91], v[34:49]
    ds_read_b128 v[144:147], v7 offset:16384
    v_mfma_f32_32x32x16_bf16 v[240:255], v[152:155], v[176:179], v[240:255]
    s_waitcnt lgkmcnt(6)
    v_mfma_f32_32x32x16_bf16 v[18:33], v[64:67], v[92:95], v[18:33]
    ds_read_b128 v[132:135], v7 offset:17408
    v_mfma_f32_32x32x16_bf16 v[224:239], v[64:67], v[180:183], v[224:239]
    s_waitcnt lgkmcnt(6)
    v_mfma_f32_32x32x16_bf16 v[34:49], v[128:131], v[92:95], v[34:49]
    ds_read_b128 v[56:59], v7 offset:18432
    v_mfma_f32_32x32x16_bf16 v[240:255], v[128:131], v[180:183], v[240:255]
    s_waitcnt lgkmcnt(6)
    v_mfma_f32_32x32x16_bf16 v[18:33], v[156:159], v[96:99], v[18:33]
    ds_read_b128 v[148:151], v7 offset:19456
    v_mfma_f32_32x32x16_bf16 v[224:239], v[156:159], v[184:187], v[224:239]
    s_waitcnt lgkmcnt(6)
    v_mfma_f32_32x32x16_bf16 v[34:49], v[140:143], v[96:99], v[34:49]
    ds_read_b128 v[60:63], v7 offset:20480
    v_mfma_f32_32x32x16_bf16 v[240:255], v[140:143], v[184:187], v[240:255]
    s_waitcnt lgkmcnt(6)
    v_mfma_f32_32x32x16_bf16 v[18:33], v[68:71], v[100:103], v[18:33]
    ds_read_b128 v[136:139], v7 offset:21504
    v_mfma_f32_32x32x16_bf16 v[224:239], v[68:71], v[188:191], v[224:239]
    s_waitcnt lgkmcnt(6)
    v_mfma_f32_32x32x16_bf16 v[34:49], v[52:55], v[100:103], v[34:49]
    ds_read_b128 v[152:155], v7 offset:22528
    v_mfma_f32_32x32x16_bf16 v[240:255], v[52:55], v[188:191], v[240:255]
    s_waitcnt lgkmcnt(6)
    v_mfma_f32_32x32x16_bf16 v[18:33], v[144:147], v[104:107], v[18:33]
    ds_read_b128 v[64:67], v7 offset:23552
    v_mfma_f32_32x32x16_bf16 v[224:239], v[144:147], v[192:195], v[224:239]
    s_waitcnt lgkmcnt(6)
    v_mfma_f32_32x32x16_bf16 v[34:49], v[132:135], v[104:107], v[34:49]
    ds_read_b128 v[128:131], v7 offset:24576
    v_mfma_f32_32x32x16_bf16 v[240:255], v[132:135], v[192:195], v[240:255]
    s_waitcnt lgkmcnt(6)
    v_mfma_f32_32x32x16_bf16 v[18:33], v[56:59], v[108:111], v[18:33]
    ds_read_b128 v[156:159], v7 offset:25600
    v_mfma_f32_32x32x16_bf16 v[224:239], v[56:59], v[196:199], v[224:239]
    s_waitcnt lgkmcnt(6)
    v_mfma_f32_32x32x16_bf16 v[34:49], v[148:151], v[108:111], v[34:49]
    ds_read_b128 v[140:143], v7 offset:26624
    v_mfma_f32_32x32x16_bf16 v[240:255], v[148:151], v[196:199], v[240:255]
    s_waitcnt lgkmcnt(6)
    v_mfma_f32_32x32x16_bf16 v[18:33], v[60:63], v[112:115], v[18:33]
    ds_read_b128 v[68:71], v7 offset:27648
    v_mfma_f32_32x32x16_bf16 v[224:239], v[60:63], v[200:203], v[224:239]
    s_waitcnt lgkmcnt(6)
    v_mfma_f32_32x32x16_bf16 v[34:49], v[136:139], v[112:115], v[34:49]
    ds_read_b128 v[52:55], v7 offset:28672
    buffer_load_dwordx2 v[2:3], v4, s[28:31], s62 offen sc1
    v_mfma_f32_32x32x16_bf16 v[240:255], v[136:139], v[200:203], v[240:255]
    s_waitcnt lgkmcnt(6)
    v_mfma_f32_32x32x16_bf16 v[18:33], v[152:155], v[116:119], v[18:33]
    ds_read_b128 v[144:147], v7 offset:29696
    v_mfma_f32_32x32x16_bf16 v[224:239], v[152:155], v[204:207], v[224:239]
    s_waitcnt lgkmcnt(6)
    v_mfma_f32_32x32x16_bf16 v[34:49], v[64:67], v[116:119], v[34:49]
    v_mfma_f32_32x32x16_bf16 v[240:255], v[64:67], v[204:207], v[240:255]
    s_waitcnt lgkmcnt(5)
    v_mfma_f32_32x32x16_bf16 v[18:33], v[128:131], v[120:123], v[18:33]
    v_mfma_f32_32x32x16_bf16 v[224:239], v[128:131], v[208:211], v[224:239]
    s_waitcnt lgkmcnt(4)
    v_mfma_f32_32x32x16_bf16 v[34:49], v[156:159], v[120:123], v[34:49]
    v_mfma_f32_32x32x16_bf16 v[240:255], v[156:159], v[208:211], v[240:255]
    s_waitcnt lgkmcnt(3)
    v_mfma_f32_32x32x16_bf16 v[18:33], v[140:143], v[124:127], v[18:33]
    v_mfma_f32_32x32x16_bf16 v[224:239], v[140:143], v[212:215], v[224:239]
    s_waitcnt lgkmcnt(2)
    v_mfma_f32_32x32x16_bf16 v[34:49], v[68:71], v[124:127], v[34:49]
    buffer_load_dwordx2 v[50:51], v4, s[28:31], s62 offen sc1
    v_mfma_f32_32x32x16_bf16 v[240:255], v[68:71], v[212:215], v[240:255]
    s_waitcnt lgkmcnt(1)
    v_mfma_f32_32x32x16_bf16 v[34:49], v[52:55], v[10:13], v[34:49]
    v_mfma_f32_32x32x16_bf16 v[240:255], v[52:55], v[216:219], v[240:255]
    s_waitcnt lgkmcnt(0)
    v_mfma_f32_32x32x16_bf16 v[34:49], v[144:147], v[14:17], v[34:49]
    v_mfma_f32_32x32x16_bf16 v[240:255], v[144:147], v[220:223], v[240:255]
    s_nop 10
    v_mul_f32 v8, v18, v34
    v_mul_f32 v14, v19, v35
    v_fmac_f32 v8, v20, v36
    v_fmac_f32 v14, v21, v37
    v_fmac_f32 v8, v22, v38
    v_fmac_f32 v14, v23, v39
    v_fmac_f32 v8, v24, v40
    v_fmac_f32 v14, v25, v41
    v_fmac_f32 v8, v26, v42
    v_fmac_f32 v14, v27, v43
    v_fmac_f32 v8, v28, v44
    v_fmac_f32 v14, v29, v45
    v_fmac_f32 v8, v30, v46
    v_fmac_f32 v14, v31, v47
    v_fmac_f32 v8, v32, v48
    v_fmac_f32 v14, v33, v49
    v_mul_f32 v9, v224, v240
    v_mul_f32 v15, v225, v241
    v_fmac_f32 v9, v226, v242
    v_fmac_f32 v15, v227, v243
    v_fmac_f32 v9, v228, v244
    v_fmac_f32 v15, v229, v245
    v_fmac_f32 v9, v230, v246
    v_fmac_f32 v15, v231, v247
    v_fmac_f32 v9, v232, v248
    v_fmac_f32 v15, v233, v249
    v_fmac_f32 v9, v234, v250
    v_fmac_f32 v15, v235, v251
    v_fmac_f32 v9, v236, v252
    v_fmac_f32 v15, v237, v253
    v_fmac_f32 v9, v238, v254
    v_fmac_f32 v15, v239, v255
    v_add_f32 v8, v8, v14
    v_add_f32 v9, v9, v15
    v_add_f32 v8, v8, v9
    v_mov_b32 v9, s27
    s_mov_b32 s58, 0x3ffffff
    s_waitcnt vmcnt(1)
    v_cmp_ne_u32 vcc, v9, v3
    s_nop 0
    s_and_b32 vcc_lo, vcc_lo, s58
    s_cbranch_scc1 L_secondH
L_ok0H:
    v_add_f32 v8, v8, v2
L_okH:
    s_nop 1
    v_add_f32_dpp v8, v8, v8 row_shr:1 row_mask:0xf bank_mask:0xf bound_ctrl:1
    s_nop 1
    v_add_f32_dpp v8, v8, v8 row_shr:2 row_mask:0xf bank_mask:0xf bound_ctrl:1
    s_nop 1
    v_add_f32_dpp v8, v8, v8 row_shr:4 row_mask:0xf bank_mask:0xf bound_ctrl:1
    s_nop 1
    v_add_f32_dpp v8, v8, v8 row_shr:8 row_mask:0xf bank_mask:0xf bound_ctrl:1
    s_nop 1
    v_add_f32_dpp v8, v8, v8 row_bcast:15 row_mask:0xa bank_mask:0xf
    s_nop 1
    v_add_f32_dpp v8, v8, v8 row_bcast:31 row_mask:0xc bank_mask:0xf
    v_add_f32 v8, s63, v8
    v_cmp_eq_u32 vcc, 63, v1
    v_cvt_pk_bf16_f32 v8, v8, v8
    s_nop 0
    v_cndmask_b32 v5, v5, 0, vcc
    buffer_store_short v8, v5, s[88:91], s61 offen
    s_endpgm
L_secondH:
    s_waitcnt vmcnt(0)
    v_mov_b32 v2, v50
    v_cmp_ne_u32 vcc, v9, v51
    s_nop 0
    s_and_b32 vcc_lo, vcc_lo, s58
    s_cbranch_scc0 L_ok0H
L_slowH:
    s_sub_u32 s92, s92, 1
    s_cbranch_scc1 L_exit
    s_mov_b32 exec_lo, vcc_lo
    s_mov_b32 exec_hi, 0
    buffer_load_dwordx2 v[2:3], v4, s[28:31], s62 offen sc1
    s_waitcnt vmcnt(0)
    v_cmp_ne_u32 vcc, v9, v3
    s_nop 0
    s_and_b32 vcc_lo, vcc_lo, s58
    s_cbranch_scc1 L_slowH
    s_mov_b64 exec, -1
    s_branch L_ok0H
L_exit:
    s_endpgm
.section .rodata,"a"
.p2align 6
.amdhsa_kernel standalone__deep_cross_xdeepfm__recsys_kernel
  .amdhsa_next_free_vgpr 256
  .amdhsa_next_free_sgpr 102
  .amdhsa_accum_offset 256
  .amdhsa_group_segment_fixed_size 0
  .amdhsa_float_denorm_mode_32 3
  .amdhsa_kernarg_size 88
  .amdhsa_user_sgpr_count 2
  .amdhsa_user_sgpr_kernarg_segment_ptr 1
  .amdhsa_system_sgpr_workgroup_id_x 1
.end_amdhsa_kernel
```
